```python
import torch

def _softmax(x, axis=-1):
    return torch.softmax(x, dim=axis)
def _gelu(x):
    return torch.nn.functional.gelu(x, approximate="tanh")
def _silu(x):
    return torch.nn.functional.silu(x)
def _sigmoid(x):
    return torch.sigmoid(x)
def _layernorm(x, axis=-1, eps=1e-5):
    m = x.mean(dim=axis, keepdim=True)
    v = x.var(dim=axis, keepdim=True, unbiased=False)
    return (x - m) / torch.sqrt(v + eps)
def _scatter_add(tgt, idx, src, axis=0):
    return tgt.clone().index_add_(axis, idx, src)
def _segment_sum(src, seg, n):
    out = torch.zeros((n,) + src.shape[1:], dtype=src.dtype)
    return out.index_add_(0, seg, src)
def _pad(x, pw):
    flat = tuple(v for pair in reversed(pw) for v in pair)
    return torch.nn.functional.pad(x, flat)

kernel_name = 'standalone__gqa_softmax__near_ridge'

def setup_inputs():

    _w = (lambda a: (lambda t: t.to(torch.bfloat16) if t.is_floating_point() else t)(torch.as_tensor(a)))
    B, Hq, Hkv, Sq, Sk, D = 8, 16, 8, 144, 1024, 256
    return {
        "q": _w((lambda *s: torch.randn(*s, dtype=torch.bfloat16) * 0.8)(B, Hq, Sq, D)),
        "k": _w((lambda *s: torch.randn(*s, dtype=torch.bfloat16) * 0.8)(B, Hkv, Sk, D)),
        "v": _w((lambda *s: torch.randn(*s, dtype=torch.bfloat16) * 0.05)(B, Hkv, Sk, D)),
    }

def reference(q, k, v):
    B, Hq, Sq, D = q.shape
    Hkv = k.shape[1]
    rep = Hq // Hkv
    k = (lambda x, n, axis: torch.repeat_interleave(x, n, dim=axis))(k, rep, axis=1)
    v = (lambda x, n, axis: torch.repeat_interleave(x, n, dim=axis))(v, rep, axis=1)
    scale = D ** -0.5
    scores = torch.einsum("bhqd,bhkd->bhqk", q, k) * scale
    p = _softmax(scores, axis=-1)
    return torch.einsum("bhqk,bhkd->bhqd", p, v)
```

```asm
; @launch grid=(256,1,1) block=(256,1,1) lds=163840
.amdgcn_target "amdgcn-amd-amdhsa--gfx950"
.text
.globl standalone__gqa_softmax__near_ridge_kernel
.p2align 8
.type standalone__gqa_softmax__near_ridge_kernel,@function
standalone__gqa_softmax__near_ridge_kernel:
  s_cmp_ge_u32 s2, 256
  s_cbranch_scc1 L_done
  s_load_dwordx8 s[4:11], s[0:1], 0
  v_lshrrev_b32 v1, 6, v0
  v_and_b32 v2, 63, v0
  v_readfirstlane_b32 s28, v1
  s_and_b32 s34, s2, 7
  s_lshr_b32 s35, s2, 3
  s_lshr_b32 s36, s35, 2
  s_and_b32 s29, s35, 3
  s_lshl_b32 s34, s34, 3
  s_add_u32 s36, s36, s34
  s_mul_i32 s37, s36, 288
  s_mul_i32 s35, s29, 72
  s_add_u32 s37, s37, s35
  s_lshl_b32 s37, s37, 9
  s_lshl_b32 s36, s36, 19
  s_lshl_b32 s48, s28, 10
  s_mov_b32 s3, 32768
  s_mov_b32 s52, 0
  s_mov_b32 s53, 4096
  s_mov_b32 s54, 8192
  s_mov_b32 s55, 12288
  s_mov_b32 s56, 16384
  s_mov_b32 s57, 20480
  s_mov_b32 s58, 24576
  s_mov_b32 s59, 28672
  s_mul_i32 s30, s28, 28672
  s_add_u32 s30, s30, 43520
  s_mov_b32 s60, 0
  s_mov_b32 s61, 128
  s_mov_b32 s62, 256
  s_mov_b32 s63, 384
  s_lshl_b32 s34, s28, 4
  s_mov_b64 s[38:39], 0xffff
  s_lshl_b64 s[38:39], s[38:39], s34
  s_mov_b32 s46, 0xff0000ff
  s_mov_b32 s47, 0xff0000ff
  v_lshrrev_b32 v3, 3, v2
  v_and_b32 v4, 7, v2
  v_lshrrev_b32 v5, 4, v2
  v_xor_b32 v5, v5, v4
  v_lshlrev_b32 v5, 4, v5
  v_lshl_add_u32 v35, v3, 9, v5
  v_xor_b32 v6, 64, v35
  s_and_b32 s34, s28, 1
  s_lshl_b32 s34, s34, 6
  v_xor_b32 v34, s34, v35
  s_lshl_b32 s34, s28, 12
  v_add_u32 v34, s34, v34
  s_lshl_b32 s34, s28, 17
  v_add_u32 v10, s34, v35
  v_add_u32 v11, s34, v6
  v_add_u32 v11, 31744, v11
  v_add_u32 v12, 63488, v10
  v_add_u32 v13, 63488, v11
  v_bfe_u32 v7, v2, 4, 1
  v_lshlrev_b32 v7, 2, v7
  v_xor_b32 v7, v7, v4
  v_lshlrev_b32 v7, 4, v7
  v_lshl_add_u32 v7, v3, 9, v7
  s_lshl_b32 s34, s28, 7
  v_add_u32 v14, s34, v7
  v_add_u32 v15, 31744, v14
  v_add_u32 v16, 31744, v15
  v_add_u32 v17, 31744, v16
  s_mov_b32 s31, 0x3db8aa3b
  s_mov_b32 s33, 0
  s_mov_b32 s22, 36864
  s_mov_b32 s23, 0x20000
  s_mov_b32 s26, 36864
  s_mov_b32 s27, 0x20000
  s_sub_u32 s66, 524288, s60
  s_mov_b32 s67, 0x20000
  s_lshl_b32 s34, s60, 10
  s_sub_u32 s82, 524288, s34
  s_mov_b32 s83, 0x20000
  s_sub_u32 s70, 524288, s61
  s_mov_b32 s71, 0x20000
  s_lshl_b32 s34, s61, 10
  s_sub_u32 s86, 524288, s34
  s_mov_b32 s87, 0x20000
  s_sub_u32 s74, 524288, s62
  s_mov_b32 s75, 0x20000
  s_lshl_b32 s34, s62, 10
  s_sub_u32 s90, 524288, s34
  s_mov_b32 s91, 0x20000
  s_sub_u32 s78, 524288, s63
  s_mov_b32 s79, 0x20000
  s_lshl_b32 s34, s63, 10
  s_sub_u32 s94, 524288, s34
  s_mov_b32 s95, 0x20000
  s_waitcnt lgkmcnt(0)
  s_add_u32 s20, s4, s37
  s_addc_u32 s21, s5, 0
  s_and_b32 s21, s21, 0xffff
  s_add_u32 s12, s6, s36
  s_addc_u32 s13, s7, 0
  s_add_u32 s64, s12, s60
  s_addc_u32 s65, s13, 0
  s_and_b32 s65, s65, 0xffff
  s_add_u32 s68, s12, s61
  s_addc_u32 s69, s13, 0
  s_and_b32 s69, s69, 0xffff
  s_add_u32 s72, s12, s62
  s_addc_u32 s73, s13, 0
  s_and_b32 s73, s73, 0xffff
  s_add_u32 s76, s12, s63
  s_addc_u32 s77, s13, 0
  s_and_b32 s77, s77, 0xffff
  s_add_u32 s16, s8, s36
  s_addc_u32 s17, s9, 0
  s_lshl_b32 s34, s60, 10
  s_add_u32 s80, s16, s34
  s_addc_u32 s81, s17, 0
  s_and_b32 s81, s81, 0xffff
  s_lshl_b32 s34, s61, 10
  s_add_u32 s84, s16, s34
  s_addc_u32 s85, s17, 0
  s_and_b32 s85, s85, 0xffff
  s_lshl_b32 s34, s62, 10
  s_add_u32 s88, s16, s34
  s_addc_u32 s89, s17, 0
  s_and_b32 s89, s89, 0xffff
  s_lshl_b32 s34, s63, 10
  s_add_u32 s92, s16, s34
  s_addc_u32 s93, s17, 0
  s_and_b32 s93, s93, 0xffff
  s_add_u32 s24, s10, s37
  s_addc_u32 s25, s11, 0
  s_and_b32 s25, s25, 0xffff
L_main_v0:
  s_add_u32 m0, s48, 0
  s_nop 0
  buffer_load_dwordx4 v34, s[20:23], s60 offen lds
  s_add_u32 m0, s48, 4096
  s_add_u32 s32, s60, 16384
  buffer_load_dwordx4 v34, s[20:23], s32 offen lds
  s_mov_b32 m0, 8192
  s_add_u32 s32, s60, 32768
  s_mov_b64 exec, s[38:39]
  buffer_load_dwordx4 v35, s[20:23], s32 offen lds
  s_mov_b64 exec, -1
  s_add_u32 m0, s30, 0
  s_nop 0
  buffer_load_dwordx4 v10, s[64:67], s52 offen offset:0 lds
  buffer_load_dwordx4 v11, s[64:67], s52 offen offset:1024 lds
  buffer_load_dwordx4 v12, s[64:67], s52 offen offset:2048 lds
  buffer_load_dwordx4 v13, s[64:67], s52 offen offset:3072 lds
  s_add_u32 m0, s48, 9216
  s_nop 0
  buffer_load_dwordx4 v34, s[20:23], s61 offen lds
  s_add_u32 m0, s48, 13312
  s_add_u32 s32, s61, 16384
  buffer_load_dwordx4 v34, s[20:23], s32 offen lds
  s_mov_b32 m0, 17408
  s_add_u32 s32, s61, 32768
  s_mov_b64 exec, s[38:39]
  buffer_load_dwordx4 v35, s[20:23], s32 offen lds
  s_mov_b64 exec, -1
  v_and_b32 v3, 31, v2
  v_lshrrev_b32 v4, 5, v2
  v_bfe_u32 v5, v2, 1, 3
  v_xor_b32 v5, v5, v4
  v_lshlrev_b32 v5, 4, v5
  v_lshl_add_u32 v5, v3, 7, v5
  v_xor_b32 v232, 0, v5
  v_add_u32 v18, s30, v232
  v_xor_b32 v233, 32, v5
  v_add_u32 v19, s30, v233
  v_xor_b32 v234, 64, v5
  v_add_u32 v20, s30, v234
  v_xor_b32 v235, 96, v5
  v_add_u32 v21, s30, v235
  v_and_b32 v5, 7, v2
  v_bfe_u32 v6, v2, 1, 2
  v_xor_b32 v6, v6, v4
  v_lshlrev_b32 v6, 4, v6
  v_lshl_add_u32 v6, v5, 7, v6
  v_xor_b32 v60, 0, v6
  v_xor_b32 v61, 32, v6
  v_xor_b32 v62, 64, v6
  v_xor_b32 v63, 96, v6
  v_bfe_u32 v5, v2, 2, 2
  v_lshl_add_u32 v5, v4, 2, v5
  v_bfe_u32 v6, v2, 4, 1
  v_bfe_u32 v7, v2, 1, 1
  v_lshl_add_u32 v6, v6, 1, v7
  v_bfe_u32 v7, v2, 3, 1
  v_lshl_add_u32 v6, v7, 2, v6
  v_lshlrev_b32 v6, 4, v6
  v_lshl_add_u32 v6, v5, 7, v6
  v_and_b32 v7, 1, v2
  v_lshl_add_u32 v6, v7, 3, v6
  v_add_u32 v22, s30, v6
  v_xor_b32 v6, 64, v6
  v_add_u32 v23, s30, v6
  v_lshlrev_b32 v9, 4, v2
  s_lshl_b32 s34, s28, 12
  v_add_u32 v24, s34, v9
  s_lshl_b32 s34, s60, 5
  v_add_u32 v26, s34, v9
  s_lshl_b32 s34, s61, 5
  v_add_u32 v27, s34, v9
  s_lshl_b32 s34, s62, 5
  v_add_u32 v28, s34, v9
  s_lshl_b32 s34, s63, 5
  v_add_u32 v29, s34, v9
  v_and_b32 v5, 7, v2
  v_lshlrev_b32 v5, 5, v5
  v_bfe_u32 v6, v2, 3, 1
  v_lshl_add_u32 v7, v6, 9, v5
  v_bfe_u32 v8, v2, 4, 1
  v_lshl_add_u32 v7, v8, 4, v7
  v_lshl_add_u32 v7, v4, 3, v7
  s_add_u32 s34, s48, 16384
  v_add_u32 v25, s34, v7
  v_xor_b32 v6, v6, v8
  v_lshl_add_u32 v7, v6, 8, v5
  v_lshl_add_u32 v7, v4, 4, v7
  v_add_u32 v7, 16384, v7
  s_lshl_b32 s34, s60, 3
  v_add_u32 v30, s34, v7
  s_lshl_b32 s34, s61, 3
  v_add_u32 v31, s34, v7
  s_lshl_b32 s34, s62, 3
  v_add_u32 v32, s34, v7
  s_lshl_b32 s34, s63, 3
  v_add_u32 v33, s34, v7
  v_lshlrev_b32 v5, 4, v3
  v_add_u32 v58, 40960, v5
  v_and_b32 v5, 7, v2
  v_lshlrev_b32 v5, 4, v5
  v_add_u32 v59, 41984, v5
  s_lshl_b32 s34, s28, 2
  v_add_u32 v56, s34, v58
  v_add_u32 v57, s34, v59
  s_mul_i32 s34, s33, 1280
  v_add_u32 v253, s34, v56
  v_add_u32 v254, s34, v57
  v_accvgpr_write_b32 a128, 0
  v_accvgpr_write_b32 a129, 0
  v_accvgpr_write_b32 a130, 0
  v_accvgpr_write_b32 a131, 0
  v_accvgpr_write_b32 a132, 0
  v_accvgpr_write_b32 a133, 0
  v_accvgpr_write_b32 a134, 0
  v_accvgpr_write_b32 a135, 0
  v_accvgpr_write_b32 a136, 0
  v_accvgpr_write_b32 a137, 0
  v_accvgpr_write_b32 a138, 0
  v_accvgpr_write_b32 a139, 0
  v_accvgpr_write_b32 a140, 0
  v_accvgpr_write_b32 a141, 0
  v_accvgpr_write_b32 a142, 0
  v_accvgpr_write_b32 a143, 0
  v_accvgpr_write_b32 a144, 0
  v_accvgpr_write_b32 a145, 0
  v_accvgpr_write_b32 a146, 0
  v_accvgpr_write_b32 a147, 0
  v_accvgpr_write_b32 a148, 0
  v_accvgpr_write_b32 a149, 0
  v_accvgpr_write_b32 a150, 0
  v_accvgpr_write_b32 a151, 0
  v_accvgpr_write_b32 a152, 0
  v_accvgpr_write_b32 a153, 0
  v_accvgpr_write_b32 a154, 0
  v_accvgpr_write_b32 a155, 0
  v_accvgpr_write_b32 a156, 0
  v_accvgpr_write_b32 a157, 0
  v_accvgpr_write_b32 a158, 0
  v_accvgpr_write_b32 a159, 0
  v_accvgpr_write_b32 a160, 0
  v_accvgpr_write_b32 a161, 0
  v_accvgpr_write_b32 a162, 0
  v_accvgpr_write_b32 a163, 0
  v_accvgpr_write_b32 a164, 0
  v_accvgpr_write_b32 a165, 0
  v_accvgpr_write_b32 a166, 0
  v_accvgpr_write_b32 a167, 0
  v_accvgpr_write_b32 a168, 0
  v_accvgpr_write_b32 a169, 0
  v_accvgpr_write_b32 a170, 0
  v_accvgpr_write_b32 a171, 0
  v_accvgpr_write_b32 a172, 0
  v_accvgpr_write_b32 a173, 0
  v_accvgpr_write_b32 a174, 0
  v_accvgpr_write_b32 a175, 0
  v_accvgpr_write_b32 a176, 0
  v_accvgpr_write_b32 a177, 0
  v_accvgpr_write_b32 a178, 0
  v_accvgpr_write_b32 a179, 0
  v_accvgpr_write_b32 a180, 0
  v_accvgpr_write_b32 a181, 0
  v_accvgpr_write_b32 a182, 0
  v_accvgpr_write_b32 a183, 0
  v_accvgpr_write_b32 a184, 0
  v_accvgpr_write_b32 a185, 0
  v_accvgpr_write_b32 a186, 0
  v_accvgpr_write_b32 a187, 0
  v_accvgpr_write_b32 a188, 0
  v_accvgpr_write_b32 a189, 0
  v_accvgpr_write_b32 a190, 0
  v_accvgpr_write_b32 a191, 0
  s_add_u32 m0, s30, 4096
  s_nop 0
  buffer_load_dwordx4 v10, s[68:71], s52 offen offset:0 lds
  buffer_load_dwordx4 v11, s[68:71], s52 offen offset:1024 lds
  buffer_load_dwordx4 v12, s[68:71], s52 offen offset:2048 lds
  buffer_load_dwordx4 v13, s[68:71], s52 offen offset:3072 lds
  s_waitcnt vmcnt(11)
  s_barrier
  s_add_u32 m0, s48, 18432
  s_nop 0
  buffer_load_dwordx4 v34, s[20:23], s62 offen lds
  s_add_u32 m0, s48, 22528
  s_add_u32 s32, s62, 16384
  buffer_load_dwordx4 v34, s[20:23], s32 offen lds
  s_mov_b32 m0, 26624
  s_add_u32 s32, s62, 32768
  s_mov_b64 exec, s[38:39]
  buffer_load_dwordx4 v35, s[20:23], s32 offen lds
  s_mov_b64 exec, -1
  s_add_u32 m0, s30, 8192
  s_nop 0
  buffer_load_dwordx4 v10, s[72:75], s52 offen offset:0 lds
  buffer_load_dwordx4 v11, s[72:75], s52 offen offset:1024 lds
  buffer_load_dwordx4 v12, s[72:75], s52 offen offset:2048 lds
  buffer_load_dwordx4 v13, s[72:75], s52 offen offset:3072 lds
  s_mov_b64 exec, s[46:47]
  ds_read_b128 a[128:131], v60 offset:8192
  ds_read_b128 a[132:135], v61 offset:8192
  ds_read_b128 a[136:139], v62 offset:8192
  ds_read_b128 a[140:143], v63 offset:8192
  s_mov_b64 exec, -1
  ds_read_b128 a[0:3], v232 offset:0
  ds_read_b128 a[64:67], v232 offset:4096
  s_waitcnt vmcnt(14)
  ds_read_b128 v[136:139], v18 offset:0
  s_waitcnt lgkmcnt(0)
  v_mfma_f32_32x32x16_bf16 v[64:79], v[136:139], a[0:3], 0
  ds_read_b128 a[4:7], v233 offset:0
  ds_read_b128 a[68:71], v233 offset:4096
  ds_read_b128 v[140:143], v19 offset:0
  ds_read_b128 a[8:11], v234 offset:0
  ds_read_b128 a[72:75], v234 offset:4096
  ds_read_b128 v[144:147], v20 offset:0
  v_mfma_f32_32x32x16_bf16 v[80:95], v[136:139], a[64:67], 0
  ds_read_b128 a[12:15], v235 offset:0
  ds_read_b128 a[76:79], v235 offset:4096
  ds_read_b128 v[148:151], v21 offset:0
  s_waitcnt vmcnt(11)
  s_barrier
  s_add_u32 m0, s48, 27648
  s_nop 0
  buffer_load_dwordx4 v34, s[20:23], s63 offen lds
  s_add_u32 m0, s48, 31744
  s_add_u32 s32, s63, 16384
  buffer_load_dwordx4 v34, s[20:23], s32 offen lds
  s_mov_b32 m0, 35840
  s_add_u32 s32, s63, 32768
  s_mov_b64 exec, s[38:39]
  buffer_load_dwordx4 v35, s[20:23], s32 offen lds
  s_mov_b64 exec, -1
  s_add_u32 m0, s30, 12288
  s_nop 0
  buffer_load_dwordx4 v10, s[76:79], s52 offen offset:0 lds
  buffer_load_dwordx4 v11, s[76:79], s52 offen offset:1024 lds
  buffer_load_dwordx4 v12, s[76:79], s52 offen offset:2048 lds
  buffer_load_dwordx4 v13, s[76:79], s52 offen offset:3072 lds
  v_mfma_f32_16x16x32_bf16 v[96:99], v[136:139], a[128:131], 0
  s_waitcnt vmcnt(14) lgkmcnt(6)
  v_mfma_f32_32x32x16_bf16 v[64:79], v[140:143], a[4:7], v[64:79]
  s_mov_b64 exec, s[46:47]
  ds_read_b128 a[144:147], v60 offset:17408
  ds_read_b128 a[148:151], v61 offset:17408
  ds_read_b128 a[152:155], v62 offset:17408
  ds_read_b128 a[156:159], v63 offset:17408
  s_mov_b64 exec, -1
  v_mfma_f32_32x32x16_bf16 v[80:95], v[140:143], a[68:71], v[80:95]
  ds_read_b128 a[16:19], v232 offset:9216
  ds_read_b128 a[80:83], v232 offset:13312
  ds_read_b128 v[152:155], v18 offset:4096
  ds_read_b128 a[20:23], v233 offset:9216
  ds_read_b128 a[84:87], v233 offset:13312
  s_waitcnt lgkmcnt(13)
  ds_read_b128 v[156:159], v19 offset:4096
  v_mfma_f32_16x16x32_bf16 v[96:99], v[140:143], a[132:135], v[96:99]
  ds_read_b128 a[24:27], v234 offset:9216
  s_waitcnt lgkmcnt(14)
  v_mfma_f32_32x32x16_bf16 v[64:79], v[144:147], a[8:11], v[64:79]
  ds_read_b128 a[88:91], v234 offset:13312
  s_waitcnt lgkmcnt(13)
  ds_read_b128 v[160:163], v20 offset:4096
  ds_read_b128 a[28:31], v235 offset:9216
  s_waitcnt lgkmcnt(13)
  ds_read_b128 a[92:95], v235 offset:13312
  v_mfma_f32_32x32x16_bf16 v[80:95], v[144:147], a[72:75], v[80:95]
  ds_read_b128 v[164:167], v21 offset:4096
  s_waitcnt vmcnt(11)
  s_barrier
  s_add_u32 m0, s30, 16384
  s_mov_b64 exec, s[46:47]
  s_waitcnt lgkmcnt(13)
  ds_read_b128 a[160:163], v60 offset:26624
  ds_read_b128 a[164:167], v61 offset:26624
  s_waitcnt lgkmcnt(13)
  ds_read_b128 a[168:171], v62 offset:26624
  ds_read_b128 a[172:175], v63 offset:26624
  s_mov_b64 exec, -1
  v_mfma_f32_16x16x32_bf16 v[96:99], v[144:147], a[136:139], v[96:99]
  s_waitcnt lgkmcnt(13)
  ds_read_b128 a[32:35], v232 offset:18432
  s_waitcnt vmcnt(7)
  v_mfma_f32_32x32x16_bf16 v[64:79], v[148:151], a[12:15], v[64:79]
  buffer_load_dwordx4 v10, s[64:67], s53 offen offset:0 lds
  ds_read_b128 a[96:99], v232 offset:22528
  s_waitcnt lgkmcnt(13)
  ds_read_b128 v[136:139], v18 offset:8192
  v_mfma_f32_32x32x16_bf16 v[80:95], v[148:151], a[76:79], v[80:95]
  buffer_load_dwordx4 v11, s[64:67], s53 offen offset:1024 lds
  ds_read_b128 a[36:39], v233 offset:18432
  s_waitcnt lgkmcnt(13)
  ds_read_b128 a[100:103], v233 offset:22528
  v_mfma_f32_16x16x32_bf16 v[96:99], v[148:151], a[140:143], v[96:99]
  ds_read_b128 v[140:143], v19 offset:8192
  v_mfma_f32_32x32x16_bf16 v[64:79], v[152:155], a[16:19], v[64:79]
  buffer_load_dwordx4 v12, s[64:67], s53 offen offset:2048 lds
  s_waitcnt lgkmcnt(13)
  ds_read_b128 a[40:43], v234 offset:18432
  ds_read_b128 a[104:107], v234 offset:22528
  v_mfma_f32_32x32x16_bf16 v[80:95], v[152:155], a[80:83], v[80:95]
  buffer_load_dwordx4 v13, s[64:67], s53 offen offset:3072 lds
  s_add_u32 m0, s30, 20480
  s_waitcnt lgkmcnt(13)
  ds_read_b128 v[144:147], v20 offset:8192
  v_mfma_f32_16x16x32_bf16 v[96:99], v[152:155], a[144:147], v[96:99]
  ds_read_b128 a[44:47], v235 offset:18432
  v_mfma_f32_32x32x16_bf16 v[64:79], v[156:159], a[20:23], v[64:79]
  buffer_load_dwordx4 v10, s[68:71], s53 offen offset:0 lds
  s_waitcnt lgkmcnt(13)
  ds_read_b128 a[108:111], v235 offset:22528
  ds_read_b128 v[148:151], v21 offset:8192
  v_mfma_f32_32x32x16_bf16 v[80:95], v[156:159], a[84:87], v[80:95]
  buffer_load_dwordx4 v11, s[68:71], s53 offen offset:1024 lds
  s_waitcnt vmcnt(10)
  s_barrier
  v_mfma_f32_16x16x32_bf16 v[96:99], v[156:159], a[148:151], v[96:99]
  s_waitcnt vmcnt(6)
  v_mfma_f32_32x32x16_bf16 v[64:79], v[160:163], a[24:27], v[64:79]
  buffer_load_dwordx4 v12, s[68:71], s53 offen offset:2048 lds
  v_mfma_f32_32x32x16_bf16 v[80:95], v[160:163], a[88:91], v[80:95]
  buffer_load_dwordx4 v13, s[68:71], s53 offen offset:3072 lds
  s_add_u32 m0, s30, 24576
  s_mov_b64 exec, s[46:47]
  s_waitcnt lgkmcnt(13)
  ds_read_b128 a[176:179], v60 offset:35840
  ds_read_b128 a[180:183], v61 offset:35840
  s_waitcnt lgkmcnt(13)
  ds_read_b128 a[184:187], v62 offset:35840
  ds_read_b128 a[188:191], v63 offset:35840
  s_mov_b64 exec, -1
  v_mfma_f32_16x16x32_bf16 v[96:99], v[160:163], a[152:155], v[96:99]
  s_waitcnt lgkmcnt(13)
  ds_read_b128 a[48:51], v232 offset:27648
  v_mfma_f32_32x32x16_bf16 v[64:79], v[164:167], a[28:31], v[64:79]
  buffer_load_dwordx4 v10, s[72:75], s53 offen offset:0 lds
  ds_read_b128 a[112:115], v232 offset:31744
  s_waitcnt lgkmcnt(13)
  ds_read_b128 v[152:155], v18 offset:12288
  v_mfma_f32_32x32x16_bf16 v[80:95], v[164:167], a[92:95], v[80:95]
  buffer_load_dwordx4 v11, s[72:75], s53 offen offset:1024 lds
  ds_read_b128 a[52:55], v233 offset:27648
  s_waitcnt lgkmcnt(13)
  ds_read_b128 a[116:119], v233 offset:31744
  v_mfma_f32_16x16x32_bf16 v[96:99], v[164:167], a[156:159], v[96:99]
  ds_read_b128 v[156:159], v19 offset:12288
  v_mfma_f32_32x32x16_bf16 v[64:79], v[136:139], a[32:35], v[64:79]
  buffer_load_dwordx4 v12, s[72:75], s53 offen offset:2048 lds
  s_waitcnt lgkmcnt(13)
  ds_read_b128 a[56:59], v234 offset:27648
  ds_read_b128 a[120:123], v234 offset:31744
  v_mfma_f32_32x32x16_bf16 v[80:95], v[136:139], a[96:99], v[80:95]
  buffer_load_dwordx4 v13, s[72:75], s53 offen offset:3072 lds
  s_add_u32 m0, s30, 0
  s_waitcnt lgkmcnt(13)
  ds_read_b128 v[160:163], v20 offset:12288
  v_mfma_f32_16x16x32_bf16 v[96:99], v[136:139], a[160:163], v[96:99]
  ds_read_b128 a[60:63], v235 offset:27648
  v_mfma_f32_32x32x16_bf16 v[64:79], v[140:143], a[36:39], v[64:79]
  buffer_load_dwordx4 v10, s[76:79], s53 offen offset:0 lds
  s_waitcnt lgkmcnt(13)
  ds_read_b128 a[124:127], v235 offset:31744
  ds_read_b128 v[164:167], v21 offset:12288
  v_mfma_f32_32x32x16_bf16 v[80:95], v[140:143], a[100:103], v[80:95]
  buffer_load_dwordx4 v11, s[76:79], s53 offen offset:1024 lds
  s_waitcnt vmcnt(10) lgkmcnt(13)
  ds_read_b128 v[136:139], v18 offset:16384
  v_mfma_f32_16x16x32_bf16 v[96:99], v[140:143], a[164:167], v[96:99]
  v_mfma_f32_32x32x16_bf16 v[64:79], v[144:147], a[40:43], v[64:79]
  buffer_load_dwordx4 v12, s[76:79], s53 offen offset:2048 lds
  v_mfma_f32_32x32x16_bf16 v[80:95], v[144:147], a[104:107], v[80:95]
  buffer_load_dwordx4 v13, s[76:79], s53 offen offset:3072 lds
  s_add_u32 m0, s30, 4096
  ds_read_b128 v[140:143], v19 offset:16384
  v_mfma_f32_16x16x32_bf16 v[96:99], v[144:147], a[168:171], v[96:99]
  v_mfma_f32_32x32x16_bf16 v[64:79], v[148:151], a[44:47], v[64:79]
  buffer_load_dwordx4 v10, s[64:67], s54 offen offset:0 lds
  v_mfma_f32_32x32x16_bf16 v[80:95], v[148:151], a[108:111], v[80:95]
  buffer_load_dwordx4 v11, s[64:67], s54 offen offset:1024 lds
  s_waitcnt lgkmcnt(13)
  ds_read_b128 v[144:147], v20 offset:16384
  v_mfma_f32_16x16x32_bf16 v[96:99], v[148:151], a[172:175], v[96:99]
  s_waitcnt lgkmcnt(12)
  v_mfma_f32_32x32x16_bf16 v[64:79], v[152:155], a[48:51], v[64:79]
  buffer_load_dwordx4 v12, s[64:67], s54 offen offset:2048 lds
  v_mfma_f32_32x32x16_bf16 v[80:95], v[152:155], a[112:115], v[80:95]
  ds_read_b128 v[148:151], v21 offset:16384
  v_mfma_f32_16x16x32_bf16 v[96:99], v[152:155], a[176:179], v[96:99]
  s_waitcnt lgkmcnt(10)
  v_mfma_f32_32x32x16_bf16 v[64:79], v[156:159], a[52:55], v[64:79]
  buffer_load_dwordx4 v13, s[64:67], s54 offen offset:3072 lds
  s_add_u32 m0, s30, 8192
  v_mfma_f32_32x32x16_bf16 v[80:95], v[156:159], a[116:119], v[80:95]
  s_waitcnt vmcnt(12)
  ds_read_b128 v[152:155], v18 offset:20480
  buffer_load_dwordx4 v10, s[68:71], s54 offen offset:0 lds
  v_mfma_f32_16x16x32_bf16 v[96:99], v[156:159], a[180:183], v[96:99]
  s_waitcnt lgkmcnt(8)
  v_mfma_f32_32x32x16_bf16 v[64:79], v[160:163], a[56:59], v[64:79]
  v_mfma_f32_32x32x16_bf16 v[80:95], v[160:163], a[120:123], v[80:95]
  buffer_load_dwordx4 v11, s[68:71], s54 offen offset:1024 lds
  ds_read_b128 v[156:159], v19 offset:20480
  v_mfma_f32_16x16x32_bf16 v[96:99], v[160:163], a[184:187], v[96:99]
  s_waitcnt lgkmcnt(6)
  v_mfma_f32_32x32x16_bf16 v[64:79], v[164:167], a[60:63], v[64:79]
  v_mfma_f32_32x32x16_bf16 v[80:95], v[164:167], a[124:127], v[80:95]
  buffer_load_dwordx4 v12, s[68:71], s54 offen offset:2048 lds
  ds_read_b128 v[160:163], v20 offset:20480
  v_mfma_f32_16x16x32_bf16 v[96:99], v[164:167], a[188:191], v[96:99]
  s_waitcnt lgkmcnt(6)
  v_mfma_f32_32x32x16_bf16 v[100:115], v[136:139], a[0:3], 0
  s_nop 5
  v_max3_f32 v242, v64, v65, v66
  v_max3_f32 v243, v80, v81, v82
  buffer_load_dwordx4 v13, s[68:71], s54 offen offset:3072 lds
  v_mfma_f32_32x32x16_bf16 v[116:131], v[136:139], a[64:67], 0
  s_add_u32 m0, s30, 12288
  ds_read_b128 v[164:167], v21 offset:20480
  v_max3_f32 v244, v96, v97, v98
  v_max3_f32 v242, v242, v67, v68
  v_max3_f32 v243, v243, v83, v84
  v_max_f32 v244, v244, v99
  v_mfma_f32_16x16x32_bf16 v[132:135], v[136:139], a[128:131], 0
  v_max3_f32 v242, v242, v69, v70
  s_waitcnt lgkmcnt(6)
  v_mfma_f32_32x32x16_bf16 v[100:115], v[140:143], a[4:7], v[100:115]
  buffer_load_dwordx4 v10, s[72:75], s54 offen offset:0 lds
  v_max3_f32 v243, v243, v85, v86
  v_max3_f32 v242, v242, v71, v72
  v_max3_f32 v243, v243, v87, v88
  v_mfma_f32_32x32x16_bf16 v[116:131], v[140:143], a[68:71], v[116:131]
  s_waitcnt vmcnt(13)
  ds_read_b128 v[136:139], v18 offset:24576
  v_max3_f32 v242, v242, v73, v74
  v_max3_f32 v243, v243, v89, v90
  v_max3_f32 v242, v242, v75, v76
  v_max3_f32 v243, v243, v91, v92
  v_mfma_f32_16x16x32_bf16 v[132:135], v[140:143], a[132:135], v[132:135]
  v_max3_f32 v242, v242, v77, v78
  s_waitcnt lgkmcnt(6)
  v_mfma_f32_32x32x16_bf16 v[100:115], v[144:147], a[8:11], v[100:115]
  buffer_load_dwordx4 v11, s[72:75], s54 offen offset:1024 lds
  v_max3_f32 v243, v243, v93, v94
  v_max_f32 v242, v242, v79
  v_max_f32 v243, v243, v95
  v_mfma_f32_32x32x16_bf16 v[116:131], v[144:147], a[72:75], v[116:131]
  ds_read_b128 v[140:143], v19 offset:24576
  v_max_f32_dpp v248, v244, v244 row_ror:8 row_mask:0xf bank_mask:0xf
  v_mov_b32 v246, v242
  v_mov_b32 v247, v243
  v_mov_b32 v244, v248
  v_permlane32_swap_b32 v242, v246
  v_mfma_f32_16x16x32_bf16 v[132:135], v[144:147], a[136:139], v[132:135]
  v_permlane32_swap_b32 v243, v247
  s_waitcnt lgkmcnt(6)
  v_mfma_f32_32x32x16_bf16 v[100:115], v[148:151], a[12:15], v[100:115]
  buffer_load_dwordx4 v12, s[72:75], s54 offen offset:2048 lds
  v_permlane16_swap_b32 v244, v248
  v_max_f32 v242, v242, v246
  v_max_f32 v243, v243, v247
  v_mfma_f32_32x32x16_bf16 v[116:131], v[148:151], a[76:79], v[116:131]
  ds_read_b128 v[144:147], v20 offset:24576
  v_max_f32 v244, v244, v248
  v_mov_b32 v248, v244
  s_nop 1
  v_permlane32_swap_b32 v244, v248
  v_max_f32 v244, v244, v248
  v_mfma_f32_16x16x32_bf16 v[132:135], v[148:151], a[140:143], v[132:135]
  ds_write_b32 v253, v242
  s_waitcnt lgkmcnt(7)
  v_mfma_f32_32x32x16_bf16 v[100:115], v[152:155], a[16:19], v[100:115]
  buffer_load_dwordx4 v13, s[72:75], s54 offen offset:3072 lds
  s_add_u32 m0, s30, 16384
  ds_write_b32 v253, v243 offset:512
  ds_write_b32 v254, v244
  v_mfma_f32_32x32x16_bf16 v[116:131], v[152:155], a[80:83], v[116:131]
  ds_read_b128 v[148:151], v21 offset:24576
  s_waitcnt lgkmcnt(1)
  s_barrier
  buffer_load_dwordx4 v10, s[76:79], s54 offen offset:0 lds
  v_mfma_f32_16x16x32_bf16 v[132:135], v[152:155], a[144:147], v[132:135]
  ds_read_b128 v[168:171], v58
  v_mfma_f32_32x32x16_bf16 v[100:115], v[156:159], a[20:23], v[100:115]
  ds_read_b128 v[172:175], v58 offset:512
  ds_read_b128 v[176:179], v59
  v_mov_b32 v242, 0
  v_lshl_add_u32 v243, v2, 2, s48
  ds_write_b32 v243, v242 offset:16640
  ds_write_b32 v243, v242 offset:17152
  v_mfma_f32_32x32x16_bf16 v[116:131], v[156:159], a[84:87], v[116:131]
  buffer_load_dwordx4 v11, s[76:79], s54 offen offset:1024 lds
  s_waitcnt vmcnt(14)
  ds_read_b128 v[152:155], v18 offset:0
  ds_write_b32 v243, v242 offset:37120
  v_mfma_f32_16x16x32_bf16 v[132:135], v[156:159], a[148:151], v[132:135]
  ds_write_b32 v243, v242 offset:37632
  v_mfma_f32_32x32x16_bf16 v[100:115], v[160:163], a[24:27], v[100:115]
  s_waitcnt lgkmcnt(7)
  v_max3_f32 v236, v168, v169, v170
  s_waitcnt lgkmcnt(6)
  v_max3_f32 v237, v172, v173, v174
  s_waitcnt lgkmcnt(5)
  v_max3_f32 v238, v176, v177, v178
  v_mfma_f32_32x32x16_bf16 v[116:131], v[160:163], a[88:91], v[116:131]
  buffer_load_dwordx4 v12, s[76:79], s54 offen offset:2048 lds
  ds_read_b128 v[156:159], v19 offset:0
  v_max_f32 v236, v236, v171
  v_max_f32 v237, v237, v175
  v_mfma_f32_16x16x32_bf16 v[132:135], v[160:163], a[152:155], v[132:135]
  v_max_f32 v238, v238, v179
  v_mfma_f32_32x32x16_bf16 v[100:115], v[164:167], a[28:31], v[100:115]
  v_mul_f32 v236, s31, v236
  v_mul_f32 v237, s31, v237
  v_mul_f32 v238, s31, v238
  buffer_load_dwordx4 v13, s[76:79], s54 offen offset:3072 lds
  v_mfma_f32_32x32x16_bf16 v[116:131], v[164:167], a[92:95], v[116:131]
  ds_read_b128 v[160:163], v20 offset:0
  v_fma_f32 v64, v64, s31, -v236
  v_fma_f32 v65, v65, s31, -v236
  v_exp_f32 v64, v64
  v_fma_f32 v66, v66, s31, -v236
  v_mfma_f32_16x16x32_bf16 v[132:135], v[164:167], a[156:159], v[132:135]
  s_add_u32 m0, s30, 20480
  v_mfma_f32_32x32x16_bf16 v[100:115], v[136:139], a[32:35], v[100:115]
  buffer_load_dwordx4 v14, s[80:83], s52 offen offset:0 lds
  v_exp_f32 v65, v65
  v_fma_f32 v67, v67, s31, -v236
  v_mfma_f32_32x32x16_bf16 v[116:131], v[136:139], a[96:99], v[116:131]
  ds_read_b128 v[164:167], v21 offset:0
  v_exp_f32 v66, v66
  v_fma_f32 v68, v68, s31, -v236
  v_exp_f32 v67, v67
  v_mfma_f32_16x16x32_bf16 v[132:135], v[136:139], a[160:163], v[132:135]
  v_fma_f32 v69, v69, s31, -v236
  v_mfma_f32_32x32x16_bf16 v[100:115], v[140:143], a[36:39], v[100:115]
  buffer_load_dwordx4 v15, s[80:83], s52 offen offset:1024 lds
  v_exp_f32 v68, v68
  v_fma_f32 v70, v70, s31, -v236
  v_mfma_f32_32x32x16_bf16 v[116:131], v[140:143], a[100:103], v[116:131]
  s_waitcnt vmcnt(14)
  ds_read_b128 v[136:139], v18 offset:4096
  v_exp_f32 v69, v69
  v_fma_f32 v71, v71, s31, -v236
  v_mfma_f32_16x16x32_bf16 v[132:135], v[140:143], a[164:167], v[132:135]
  v_mfma_f32_32x32x16_bf16 v[100:115], v[144:147], a[40:43], v[100:115]
  buffer_load_dwordx4 v16, s[80:83], s52 offen offset:2048 lds
  v_exp_f32 v70, v70
  v_mfma_f32_32x32x16_bf16 v[116:131], v[144:147], a[104:107], v[116:131]
  ds_read_b128 v[140:143], v19 offset:4096
  v_exp_f32 v71, v71
  v_add_f32 v239, v64, v65
  v_cvt_pk_bf16_f32 v44, v64, v65
  v_add_f32 v239, v239, v66
  v_mfma_f32_16x16x32_bf16 v[132:135], v[144:147], a[168:171], v[132:135]
  v_add_f32 v239, v239, v67
  v_mfma_f32_32x32x16_bf16 v[100:115], v[148:151], a[44:47], v[100:115]
  buffer_load_dwordx4 v17, s[80:83], s52 offen offset:3072 lds
  v_cvt_pk_bf16_f32 v45, v66, v67
  v_add_f32 v239, v239, v68
  v_add_f32 v239, v239, v69
  v_mfma_f32_32x32x16_bf16 v[116:131], v[148:151], a[108:111], v[116:131]
  ds_read_b128 v[144:147], v20 offset:4096
  v_cvt_pk_bf16_f32 v46, v68, v69
  v_add_f32 v239, v239, v70
  v_add_f32 v239, v239, v71
  v_cvt_pk_bf16_f32 v47, v70, v71
  v_fma_f32 v80, v80, s31, -v237
  v_mfma_f32_16x16x32_bf16 v[132:135], v[148:151], a[172:175], v[132:135]
  s_add_u32 m0, s30, 24576
  s_waitcnt lgkmcnt(8)
  v_mfma_f32_32x32x16_bf16 v[100:115], v[152:155], a[48:51], v[100:115]
  buffer_load_dwordx4 v14, s[84:87], s52 offen offset:0 lds
  v_fma_f32 v81, v81, s31, -v237
  v_exp_f32 v80, v80
  v_mfma_f32_32x32x16_bf16 v[116:131], v[152:155], a[112:115], v[116:131]
  buffer_load_dwordx4 v15, s[84:87], s52 offen offset:1024 lds
  ds_read_b128 v[148:151], v21 offset:4096
  v_fma_f32 v82, v82, s31, -v237
  v_mfma_f32_16x16x32_bf16 v[132:135], v[152:155], a[176:179], v[132:135]
  s_waitcnt lgkmcnt(6)
  v_mfma_f32_32x32x16_bf16 v[100:115], v[156:159], a[52:55], v[100:115]
  v_exp_f32 v81, v81
  v_fma_f32 v83, v83, s31, -v237
  v_exp_f32 v82, v82
  v_fma_f32 v84, v84, s31, -v237
  v_mfma_f32_32x32x16_bf16 v[116:131], v[156:159], a[116:119], v[116:131]
  buffer_load_dwordx4 v16, s[84:87], s52 offen offset:2048 lds
  s_waitcnt vmcnt(15)
  ds_read_b128 v[152:155], v18 offset:8192
  v_mfma_f32_16x16x32_bf16 v[132:135], v[156:159], a[180:183], v[132:135]
  s_waitcnt lgkmcnt(6)
  v_mfma_f32_32x32x16_bf16 v[100:115], v[160:163], a[56:59], v[100:115]
  v_exp_f32 v83, v83
  v_fma_f32 v85, v85, s31, -v237
  buffer_load_dwordx4 v17, s[84:87], s52 offen offset:3072 lds
  v_mfma_f32_32x32x16_bf16 v[116:131], v[160:163], a[120:123], v[116:131]
  ds_read_b128 v[156:159], v19 offset:8192
  v_exp_f32 v84, v84
  v_fma_f32 v86, v86, s31, -v237
  v_exp_f32 v85, v85
  v_mfma_f32_16x16x32_bf16 v[132:135], v[160:163], a[184:187], v[132:135]
  v_fma_f32 v87, v87, s31, -v237
  s_waitcnt lgkmcnt(6)
  v_mfma_f32_32x32x16_bf16 v[100:115], v[164:167], a[60:63], v[100:115]
  v_exp_f32 v86, v86
  v_exp_f32 v87, v87
  v_add_f32 v240, v80, v81
  v_cvt_pk_bf16_f32 v48, v80, v81
  v_mfma_f32_32x32x16_bf16 v[116:131], v[164:167], a[124:127], v[116:131]
  ds_read_b128 v[160:163], v20 offset:8192
  v_add_f32 v240, v240, v82
  v_add_f32 v240, v240, v83
  v_cvt_pk_bf16_f32 v49, v82, v83
  v_add_f32 v240, v240, v84
  v_add_f32 v240, v240, v85
  v_mfma_f32_16x16x32_bf16 v[132:135], v[164:167], a[188:191], v[132:135]
  s_add_u32 m0, s30, 0
  v_cvt_pk_bf16_f32 v50, v84, v85
  v_add_f32 v240, v240, v86
  v_add_f32 v240, v240, v87
  v_cvt_pk_bf16_f32 v51, v86, v87
  v_fma_f32 v72, v72, s31, -v236
  v_fma_f32 v73, v73, s31, -v236
  v_exp_f32 v72, v72
  v_fma_f32 v74, v74, s31, -v236
  v_exp_f32 v73, v73
  v_fma_f32 v75, v75, s31, -v236
  v_exp_f32 v74, v74
  v_fma_f32 v76, v76, s31, -v236
  v_exp_f32 v75, v75
  v_fma_f32 v77, v77, s31, -v236
  v_exp_f32 v76, v76
  v_fma_f32 v78, v78, s31, -v236
  v_exp_f32 v77, v77
  v_fma_f32 v79, v79, s31, -v236
  v_exp_f32 v78, v78
  v_exp_f32 v79, v79
  v_add_f32 v239, v239, v72
  v_add_f32 v239, v239, v73
  v_cvt_pk_bf16_f32 v52, v72, v73
  v_add_f32 v239, v239, v74
  v_add_f32 v239, v239, v75
  v_cvt_pk_bf16_f32 v53, v74, v75
  v_add_f32 v239, v239, v76
  v_add_f32 v239, v239, v77
  v_cvt_pk_bf16_f32 v54, v76, v77
  v_add_f32 v239, v239, v78
  v_add_f32 v239, v239, v79
  v_cvt_pk_bf16_f32 v55, v78, v79
  v_fma_f32 v88, v88, s31, -v237
  v_fma_f32 v89, v89, s31, -v237
  v_exp_f32 v88, v88
  v_fma_f32 v90, v90, s31, -v237
  v_exp_f32 v89, v89
  v_fma_f32 v91, v91, s31, -v237
  v_exp_f32 v90, v90
  v_fma_f32 v92, v92, s31, -v237
  v_exp_f32 v91, v91
  v_fma_f32 v93, v93, s31, -v237
  v_exp_f32 v92, v92
  v_fma_f32 v94, v94, s31, -v237
  v_exp_f32 v93, v93
  v_fma_f32 v95, v95, s31, -v237
  v_exp_f32 v94, v94
  v_exp_f32 v95, v95
  v_add_f32 v240, v240, v88
  v_add_f32 v240, v240, v89
  v_cvt_pk_bf16_f32 v4, v88, v89
  v_add_f32 v240, v240, v90
  v_add_f32 v240, v240, v91
  v_cvt_pk_bf16_f32 v5, v90, v91
  v_add_f32 v240, v240, v92
  v_add_f32 v240, v240, v93
  v_cvt_pk_bf16_f32 v6, v92, v93
  v_add_f32 v240, v240, v94
  v_add_f32 v240, v240, v95
  v_cvt_pk_bf16_f32 v7, v94, v95
  v_fma_f32 v96, v96, s31, -v238
  v_fma_f32 v97, v97, s31, -v238
  v_exp_f32 v96, v96
  v_fma_f32 v98, v98, s31, -v238
  v_exp_f32 v97, v97
  v_fma_f32 v99, v99, s31, -v238
  v_exp_f32 v98, v98
  v_exp_f32 v99, v99
  v_add_f32 v241, v96, v97
  v_cvt_pk_bf16_f32 v8, v96, v97
  v_add_f32 v241, v241, v98
  v_add_f32 v241, v241, v99
  v_cvt_pk_bf16_f32 v9, v98, v99
  ds_write_b128 v24, v[44:47] offset:0
  ds_write_b128 v24, v[48:51] offset:1024
  ds_write_b128 v24, v[52:55] offset:2048
  ds_write_b128 v24, v[4:7] offset:3072
  ds_write_b64 v25, v[8:9] offset:0
  s_waitcnt lgkmcnt(0)
  s_barrier
  v_mfma_f32_32x32x16_bf16 v[64:79], v[136:139], a[0:3], 0
  buffer_load_dwordx4 v14, s[88:91], s52 offen offset:0 lds
  v_fma_f32 v100, v100, s31, -v236
  v_fma_f32 v101, v101, s31, -v236
  v_mfma_f32_32x32x16_bf16 v[80:95], v[136:139], a[64:67], 0
  buffer_load_dwordx4 v15, s[88:91], s52 offen offset:1024 lds
  ds_read_b128 v[164:167], v21 offset:8192
  v_exp_f32 v100, v100
  v_mfma_f32_16x16x32_bf16 v[96:99], v[136:139], a[128:131], 0
  v_fma_f32 v102, v102, s31, -v236
  v_mfma_f32_32x32x16_bf16 v[64:79], v[140:143], a[4:7], v[64:79]
  buffer_load_dwordx4 v16, s[88:91], s52 offen offset:2048 lds
  v_exp_f32 v101, v101
  v_fma_f32 v103, v103, s31, -v236
  v_mfma_f32_32x32x16_bf16 v[80:95], v[140:143], a[68:71], v[80:95]
  s_waitcnt vmcnt(15)
  ds_read_b128 v[136:139], v18 offset:12288
  v_exp_f32 v102, v102
  v_fma_f32 v104, v104, s31, -v236
  v_mfma_f32_16x16x32_bf16 v[96:99], v[140:143], a[132:135], v[96:99]
  v_mfma_f32_32x32x16_bf16 v[64:79], v[144:147], a[8:11], v[64:79]
  buffer_load_dwordx4 v17, s[88:91], s52 offen offset:3072 lds
  v_exp_f32 v103, v103
  v_fma_f32 v105, v105, s31, -v236
  v_mfma_f32_32x32x16_bf16 v[80:95], v[144:147], a[72:75], v[80:95]
  ds_read_b128 v[140:143], v19 offset:12288
  v_exp_f32 v104, v104
  v_fma_f32 v106, v106, s31, -v236
  v_exp_f32 v105, v105
  v_mfma_f32_16x16x32_bf16 v[96:99], v[144:147], a[136:139], v[96:99]
  v_fma_f32 v107, v107, s31, -v236
  v_mfma_f32_32x32x16_bf16 v[64:79], v[148:151], a[12:15], v[64:79]
  v_exp_f32 v106, v106
  v_exp_f32 v107, v107
  v_mfma_f32_32x32x16_bf16 v[80:95], v[148:151], a[76:79], v[80:95]
  ds_read_b128 v[144:147], v20 offset:12288
  v_add_f32 v239, v239, v100
  v_add_f32 v239, v239, v101
  v_mfma_f32_16x16x32_bf16 v[96:99], v[148:151], a[140:143], v[96:99]
  s_add_u32 m0, s30, 4096
  v_mfma_f32_32x32x16_bf16 v[64:79], v[152:155], a[16:19], v[64:79]
  buffer_load_dwordx4 v14, s[92:95], s52 offen offset:0 lds
  v_cvt_pk_bf16_f32 v44, v100, v101
  v_add_f32 v239, v239, v102
  v_add_f32 v239, v239, v103
  v_mfma_f32_32x32x16_bf16 v[80:95], v[152:155], a[80:83], v[80:95]
  buffer_load_dwordx4 v15, s[92:95], s52 offen offset:1024 lds
  ds_read_b128 v[148:151], v21 offset:12288
  v_cvt_pk_bf16_f32 v45, v102, v103
  v_add_f32 v239, v239, v104
  v_mfma_f32_16x16x32_bf16 v[96:99], v[152:155], a[144:147], v[96:99]
  v_add_f32 v239, v239, v105
  v_mfma_f32_32x32x16_bf16 v[64:79], v[156:159], a[20:23], v[64:79]
  buffer_load_dwordx4 v16, s[92:95], s52 offen offset:2048 lds
  v_cvt_pk_bf16_f32 v46, v104, v105
  v_add_f32 v239, v239, v106
  v_add_f32 v239, v239, v107
  v_mfma_f32_32x32x16_bf16 v[80:95], v[156:159], a[84:87], v[80:95]
  s_waitcnt vmcnt(15)
  ds_read_b128 v[152:155], v18 offset:16384
  v_cvt_pk_bf16_f32 v47, v106, v107
  v_fma_f32 v116, v116, s31, -v237
  v_fma_f32 v117, v117, s31, -v237
  v_mfma_f32_16x16x32_bf16 v[96:99], v[156:159], a[148:151], v[96:99]
  v_mfma_f32_32x32x16_bf16 v[64:79], v[160:163], a[24:27], v[64:79]
  buffer_load_dwordx4 v17, s[92:95], s52 offen offset:3072 lds
  v_exp_f32 v116, v116
  v_fma_f32 v118, v118, s31, -v237
  v_mfma_f32_32x32x16_bf16 v[80:95], v[160:163], a[88:91], v[80:95]
  ds_read_b128 v[156:159], v19 offset:16384
  v_exp_f32 v117, v117
  v_fma_f32 v119, v119, s31, -v237
  v_exp_f32 v118, v118
  v_mfma_f32_16x16x32_bf16 v[96:99], v[160:163], a[152:155], v[96:99]
  v_fma_f32 v120, v120, s31, -v237
  s_waitcnt lgkmcnt(6)
  v_mfma_f32_32x32x16_bf16 v[64:79], v[164:167], a[28:31], v[64:79]
  v_exp_f32 v119, v119
  v_mfma_f32_32x32x16_bf16 v[80:95], v[164:167], a[92:95], v[80:95]
  ds_read_b128 v[160:163], v20 offset:16384
  v_fma_f32 v121, v121, s31, -v237
  v_exp_f32 v120, v120
  v_mfma_f32_16x16x32_bf16 v[96:99], v[164:167], a[156:159], v[96:99]
  s_add_u32 m0, s30, 8192
  s_waitcnt lgkmcnt(6)
  v_mfma_f32_32x32x16_bf16 v[64:79], v[136:139], a[32:35], v[64:79]
  buffer_load_dwordx4 v10, s[64:67], s55 offen offset:0 lds
  v_fma_f32 v122, v122, s31, -v237
  v_exp_f32 v121, v121
  v_mfma_f32_32x32x16_bf16 v[80:95], v[136:139], a[96:99], v[80:95]
  buffer_load_dwordx4 v11, s[64:67], s55 offen offset:1024 lds
  ds_read_b128 v[164:167], v21 offset:16384
  v_fma_f32 v123, v123, s31, -v237
  v_mfma_f32_16x16x32_bf16 v[96:99], v[136:139], a[160:163], v[96:99]
  s_waitcnt lgkmcnt(6)
  v_mfma_f32_32x32x16_bf16 v[64:79], v[140:143], a[36:39], v[64:79]
  buffer_load_dwordx4 v12, s[64:67], s55 offen offset:2048 lds
  v_exp_f32 v122, v122
  v_mfma_f32_32x32x16_bf16 v[80:95], v[140:143], a[100:103], v[80:95]
  s_waitcnt vmcnt(15)
  ds_read_b64_tr_b16 a[192:193], v22 offset:20480
  ds_read_b64_tr_b16 a[194:195], v22 offset:21504
  ds_read_b128 a[200:203], v26 offset:0
  ds_read_b128 a[204:207], v26 offset:1024
  ds_read_b128 a[208:211], v30 offset:0
  v_mfma_f32_16x16x32_bf16 v[96:99], v[140:143], a[164:167], v[96:99]
  ds_read_b64_tr_b16 a[196:197], v23 offset:20480
  s_waitcnt lgkmcnt(11)
  v_mfma_f32_32x32x16_bf16 v[64:79], v[144:147], a[40:43], v[64:79]
  buffer_load_dwordx4 v13, s[64:67], s55 offen offset:3072 lds
  ds_read_b64_tr_b16 a[198:199], v23 offset:21504
  v_exp_f32 v123, v123
  v_mfma_f32_32x32x16_bf16 v[80:95], v[144:147], a[104:107], v[80:95]
  v_add_f32 v240, v240, v116
  v_add_f32 v240, v240, v117
  v_cvt_pk_bf16_f32 v48, v116, v117
  v_add_f32 v240, v240, v118
  v_add_f32 v240, v240, v119
  v_cvt_pk_bf16_f32 v49, v118, v119
  v_mfma_f32_16x16x32_bf16 v[96:99], v[144:147], a[168:171], v[96:99]
  v_add_f32 v240, v240, v120
  s_waitcnt lgkmcnt(11)
  v_mfma_f32_32x32x16_bf16 v[64:79], v[148:151], a[44:47], v[64:79]
  v_add_f32 v240, v240, v121
  v_cvt_pk_bf16_f32 v50, v120, v121
  v_add_f32 v240, v240, v122
  v_add_f32 v240, v240, v123
  v_cvt_pk_bf16_f32 v51, v122, v123
  v_fma_f32 v108, v108, s31, -v236
  v_mfma_f32_32x32x16_bf16 v[80:95], v[148:151], a[108:111], v[80:95]
  ds_read_b64_tr_b16 a[212:213], v22 offset:22528
  ds_read_b64_tr_b16 a[214:215], v22 offset:23552
  ds_read_b128 a[220:223], v26 offset:2048
  ds_read_b128 a[224:227], v26 offset:3072
  s_waitcnt lgkmcnt(13)
  ds_read_b128 a[228:231], v30 offset:512
  v_mfma_f32_16x16x32_bf16 v[96:99], v[148:151], a[172:175], v[96:99]
  s_add_u32 m0, s30, 12288
  v_mfma_f32_32x32x16_bf16 v[64:79], v[152:155], a[48:51], v[64:79]
  buffer_load_dwordx4 v10, s[68:71], s55 offen offset:0 lds
  ds_read_b64_tr_b16 a[216:217], v23 offset:22528
  s_waitcnt lgkmcnt(13)
  ds_read_b64_tr_b16 a[218:219], v23 offset:23552
  v_mfma_f32_32x32x16_bf16 v[80:95], v[152:155], a[112:115], v[80:95]
  buffer_load_dwordx4 v11, s[68:71], s55 offen offset:1024 lds
  v_fma_f32 v109, v109, s31, -v236
  v_exp_f32 v108, v108
  v_mfma_f32_16x16x32_bf16 v[96:99], v[152:155], a[176:179], v[96:99]
  v_fma_f32 v110, v110, s31, -v236
  v_mfma_f32_32x32x16_bf16 v[64:79], v[156:159], a[52:55], v[64:79]
  buffer_load_dwordx4 v12, s[68:71], s55 offen offset:2048 lds
  v_exp_f32 v109, v109
  v_fma_f32 v111, v111, s31, -v236
  v_mfma_f32_32x32x16_bf16 v[80:95], v[156:159], a[116:119], v[80:95]
  s_waitcnt vmcnt(15)
  ds_read_b64_tr_b16 a[232:233], v22 offset:24576
  s_waitcnt lgkmcnt(13)
  ds_read_b64_tr_b16 a[234:235], v22 offset:25600
  ds_read_b128 a[240:243], v27 offset:0
  s_waitcnt lgkmcnt(13)
  ds_read_b128 a[244:247], v27 offset:1024
  v_mfma_f32_16x16x32_bf16 v[96:99], v[156:159], a[180:183], v[96:99]
  ds_read_b128 a[248:251], v31 offset:0
  v_mfma_f32_32x32x16_bf16 v[64:79], v[160:163], a[56:59], v[64:79]
  buffer_load_dwordx4 v13, s[68:71], s55 offen offset:3072 lds
  s_waitcnt lgkmcnt(13)
  ds_read_b64_tr_b16 a[236:237], v23 offset:24576
  ds_read_b64_tr_b16 a[238:239], v23 offset:25600
  v_mfma_f32_32x32x16_bf16 v[80:95], v[160:163], a[120:123], v[80:95]
  v_exp_f32 v110, v110
  v_fma_f32 v112, v112, s31, -v236
  v_exp_f32 v111, v111
  v_fma_f32 v113, v113, s31, -v236
  v_mfma_f32_16x16x32_bf16 v[96:99], v[160:163], a[184:187], v[96:99]
  v_mfma_f32_32x32x16_bf16 v[64:79], v[164:167], a[60:63], v[64:79]
  v_exp_f32 v112, v112
  v_fma_f32 v114, v114, s31, -v236
  v_exp_f32 v113, v113
  v_fma_f32 v115, v115, s31, -v236
  v_mfma_f32_32x32x16_bf16 v[80:95], v[164:167], a[124:127], v[80:95]
  v_exp_f32 v114, v114
  v_exp_f32 v115, v115
  v_add_f32 v239, v239, v108
  v_add_f32 v239, v239, v109
  v_mfma_f32_16x16x32_bf16 v[96:99], v[164:167], a[188:191], v[96:99]
  s_add_u32 m0, s30, 16384
  s_waitcnt lgkmcnt(14)
  v_mfma_f32_32x32x16_bf16 v[168:183], a[192:195], a[200:203], 0
  buffer_load_dwordx4 v10, s[72:75], s55 offen offset:0 lds
  v_cvt_pk_bf16_f32 v52, v108, v109
  v_add_f32 v239, v239, v110
  v_add_f32 v239, v239, v111
  v_mfma_f32_32x32x16_bf16 v[200:215], a[192:195], a[204:207], 0
  buffer_load_dwordx4 v11, s[72:75], s55 offen offset:1024 lds
  v_cvt_pk_bf16_f32 v53, v110, v111
  v_add_f32 v239, v239, v112
  v_add_f32 v239, v239, v113
  v_mfma_f32_16x16x32_bf16 v[36:39], a[192:195], a[208:211], 0
  v_cvt_pk_bf16_f32 v54, v112, v113
  v_add_f32 v239, v239, v114
  v_mfma_f32_32x32x16_bf16 v[184:199], a[196:199], a[200:203], 0
  buffer_load_dwordx4 v12, s[72:75], s55 offen offset:2048 lds
  v_add_f32 v239, v239, v115
  v_cvt_pk_bf16_f32 v55, v114, v115
  v_fma_f32 v124, v124, s31, -v237
  v_mfma_f32_32x32x16_bf16 v[216:231], a[196:199], a[204:207], 0
  v_fma_f32 v125, v125, s31, -v237
  v_exp_f32 v124, v124
  v_mfma_f32_16x16x32_bf16 v[40:43], a[196:199], a[208:211], 0
  ds_read_b64_tr_b16 a[192:193], v22 offset:26624
  s_waitcnt lgkmcnt(8)
  v_mfma_f32_32x32x16_bf16 v[168:183], a[212:215], a[220:223], v[168:183]
  buffer_load_dwordx4 v13, s[72:75], s55 offen offset:3072 lds
  ds_read_b64_tr_b16 a[194:195], v22 offset:27648
  ds_read_b128 a[200:203], v27 offset:2048
  ds_read_b128 a[204:207], v27 offset:3072
  v_mfma_f32_32x32x16_bf16 v[200:215], a[212:215], a[224:227], v[200:215]
  ds_read_b128 a[208:211], v31 offset:512
  ds_read_b64_tr_b16 a[196:197], v23 offset:26624
  ds_read_b64_tr_b16 a[198:199], v23 offset:27648
  v_fma_f32 v126, v126, s31, -v237
  v_exp_f32 v125, v125
  v_mfma_f32_16x16x32_bf16 v[36:39], a[212:215], a[228:231], v[36:39]
  v_fma_f32 v127, v127, s31, -v237
  v_mfma_f32_32x32x16_bf16 v[184:199], a[216:219], a[220:223], v[184:199]
  v_exp_f32 v126, v126
  v_fma_f32 v128, v128, s31, -v237
  v_exp_f32 v127, v127
  v_fma_f32 v129, v129, s31, -v237
  v_mfma_f32_32x32x16_bf16 v[216:231], a[216:219], a[224:227], v[216:231]
  v_exp_f32 v128, v128
  v_fma_f32 v130, v130, s31, -v237
  v_mfma_f32_16x16x32_bf16 v[40:43], a[216:219], a[228:231], v[40:43]
  s_add_u32 m0, s30, 20480
  s_waitcnt vmcnt(16) lgkmcnt(7)
  v_mfma_f32_32x32x16_bf16 v[168:183], a[232:235], a[240:243], v[168:183]
  buffer_load_dwordx4 v10, s[76:79], s55 offen offset:0 lds
  ds_read_b64_tr_b16 a[212:213], v22 offset:0
  ds_read_b64_tr_b16 a[214:215], v22 offset:1024
  ds_read_b128 a[220:223], v28 offset:0
  v_mfma_f32_32x32x16_bf16 v[200:215], a[232:235], a[244:247], v[200:215]
  buffer_load_dwordx4 v11, s[76:79], s55 offen offset:1024 lds
  ds_read_b128 a[224:227], v28 offset:1024
  ds_read_b128 a[228:231], v32 offset:0
  ds_read_b64_tr_b16 a[216:217], v23 offset:0
  v_mfma_f32_16x16x32_bf16 v[36:39], a[232:235], a[248:251], v[36:39]
  ds_read_b64_tr_b16 a[218:219], v23 offset:1024
  v_mfma_f32_32x32x16_bf16 v[184:199], a[236:239], a[240:243], v[184:199]
  buffer_load_dwordx4 v12, s[76:79], s55 offen offset:2048 lds
  v_exp_f32 v129, v129
  v_fma_f32 v131, v131, s31, -v237
  v_mfma_f32_32x32x16_bf16 v[216:231], a[236:239], a[244:247], v[216:231]
  v_exp_f32 v130, v130
  v_exp_f32 v131, v131
  v_add_f32 v240, v240, v124
  v_add_f32 v240, v240, v125
  v_mfma_f32_16x16x32_bf16 v[40:43], a[236:239], a[248:251], v[40:43]
  ds_read_b64_tr_b16 a[232:233], v22 offset:2048
  s_waitcnt lgkmcnt(8)
  v_mfma_f32_32x32x16_bf16 v[168:183], a[192:195], a[200:203], v[168:183]
  buffer_load_dwordx4 v13, s[76:79], s55 offen offset:3072 lds
  ds_read_b64_tr_b16 a[234:235], v22 offset:3072
  ds_read_b128 a[240:243], v28 offset:2048
  ds_read_b128 a[244:247], v28 offset:3072
  v_mfma_f32_32x32x16_bf16 v[200:215], a[192:195], a[204:207], v[200:215]
  ds_read_b128 a[248:251], v32 offset:512
  ds_read_b64_tr_b16 a[236:237], v23 offset:2048
  ds_read_b64_tr_b16 a[238:239], v23 offset:3072
  v_cvt_pk_bf16_f32 v4, v124, v125
  v_add_f32 v240, v240, v126
  v_add_f32 v240, v240, v127
  v_mfma_f32_16x16x32_bf16 v[36:39], a[192:195], a[208:211], v[36:39]
  v_cvt_pk_bf16_f32 v5, v126, v127
  v_add_f32 v240, v240, v128
  v_mfma_f32_32x32x16_bf16 v[184:199], a[196:199], a[200:203], v[184:199]
  v_add_f32 v240, v240, v129
  v_cvt_pk_bf16_f32 v6, v128, v129
  v_add_f32 v240, v240, v130
  v_add_f32 v240, v240, v131
  v_cvt_pk_bf16_f32 v7, v130, v131
  v_fma_f32 v132, v132, s31, -v238
  v_mfma_f32_32x32x16_bf16 v[216:231], a[196:199], a[204:207], v[216:231]
  v_fma_f32 v133, v133, s31, -v238
  v_exp_f32 v132, v132
  v_fma_f32 v134, v134, s31, -v238
  v_mfma_f32_16x16x32_bf16 v[40:43], a[196:199], a[208:211], v[40:43]
  s_add_u32 m0, s30, 24576
  s_waitcnt vmcnt(16) lgkmcnt(7)
  v_mfma_f32_32x32x16_bf16 v[168:183], a[212:215], a[220:223], v[168:183]
  buffer_load_dwordx4 v14, s[80:83], s53 offen offset:0 lds
  ds_read_b64_tr_b16 a[192:193], v22 offset:4096
  ds_read_b64_tr_b16 a[194:195], v22 offset:5120
  ds_read_b128 a[200:203], v29 offset:0
  v_mfma_f32_32x32x16_bf16 v[200:215], a[212:215], a[224:227], v[200:215]
  buffer_load_dwordx4 v15, s[80:83], s53 offen offset:1024 lds
  ds_read_b128 a[204:207], v29 offset:1024
  ds_read_b128 a[208:211], v33 offset:0
  ds_read_b64_tr_b16 a[196:197], v23 offset:4096
  v_mfma_f32_16x16x32_bf16 v[36:39], a[212:215], a[228:231], v[36:39]
  ds_read_b64_tr_b16 a[198:199], v23 offset:5120
  v_mfma_f32_32x32x16_bf16 v[184:199], a[216:219], a[220:223], v[184:199]
  buffer_load_dwordx4 v16, s[80:83], s53 offen offset:2048 lds
  v_exp_f32 v133, v133
  v_fma_f32 v135, v135, s31, -v238
  v_mfma_f32_32x32x16_bf16 v[216:231], a[216:219], a[224:227], v[216:231]
  v_exp_f32 v134, v134
  v_exp_f32 v135, v135
  v_add_f32 v241, v241, v132
  v_add_f32 v241, v241, v133
  v_mfma_f32_16x16x32_bf16 v[40:43], a[216:219], a[228:231], v[40:43]
  ds_read_b64_tr_b16 a[212:213], v22 offset:6144
  s_waitcnt lgkmcnt(8)
  v_mfma_f32_32x32x16_bf16 v[168:183], a[232:235], a[240:243], v[168:183]
  buffer_load_dwordx4 v17, s[80:83], s53 offen offset:3072 lds
  ds_read_b64_tr_b16 a[214:215], v22 offset:7168
  ds_read_b128 a[220:223], v29 offset:2048
  ds_read_b128 a[224:227], v29 offset:3072
  v_mfma_f32_32x32x16_bf16 v[200:215], a[232:235], a[244:247], v[200:215]
  ds_read_b128 a[228:231], v33 offset:512
  ds_read_b64_tr_b16 a[216:217], v23 offset:6144
  ds_read_b64_tr_b16 a[218:219], v23 offset:7168
  s_waitcnt vmcnt(16)
  ds_read_b128 v[136:139], v18 offset:8192
  s_waitcnt lgkmcnt(13)
  ds_read_b128 v[140:143], v19 offset:8192
  v_mfma_f32_16x16x32_bf16 v[36:39], a[232:235], a[248:251], v[36:39]
  v_cvt_pk_bf16_f32 v8, v132, v133
  v_add_f32 v241, v241, v134
  v_mfma_f32_32x32x16_bf16 v[184:199], a[236:239], a[240:243], v[184:199]
  v_add_f32 v241, v241, v135
  v_cvt_pk_bf16_f32 v9, v134, v135
  ds_write_b128 v24, v[44:47] offset:20480
  s_waitcnt lgkmcnt(13)
  ds_write_b128 v24, v[48:51] offset:21504
  ds_write_b128 v24, v[52:55] offset:22528
  v_mfma_f32_32x32x16_bf16 v[216:231], a[236:239], a[244:247], v[216:231]
  s_waitcnt lgkmcnt(13)
  ds_read_b128 v[144:147], v20 offset:8192
  ds_write_b128 v24, v[4:7] offset:23552
  s_waitcnt lgkmcnt(13)
  ds_write_b64 v25, v[8:9] offset:20480
  v_mfma_f32_16x16x32_bf16 v[40:43], a[236:239], a[248:251], v[40:43]
  s_add_u32 m0, s30, 0
  v_mfma_f32_32x32x16_bf16 v[168:183], a[192:195], a[200:203], v[168:183]
  buffer_load_dwordx4 v14, s[84:87], s53 offen offset:0 lds
  v_mfma_f32_32x32x16_bf16 v[200:215], a[192:195], a[204:207], v[200:215]
  buffer_load_dwordx4 v15, s[84:87], s53 offen offset:1024 lds
  ds_read_b128 v[148:151], v21 offset:8192
  v_mfma_f32_16x16x32_bf16 v[36:39], a[192:195], a[208:211], v[36:39]
  v_mfma_f32_32x32x16_bf16 v[184:199], a[196:199], a[200:203], v[184:199]
  buffer_load_dwordx4 v16, s[84:87], s53 offen offset:2048 lds
  v_mfma_f32_32x32x16_bf16 v[216:231], a[196:199], a[204:207], v[216:231]
  s_waitcnt vmcnt(15) lgkmcnt(13)
  ds_read_b128 v[152:155], v18 offset:12288
  v_mfma_f32_16x16x32_bf16 v[40:43], a[196:199], a[208:211], v[40:43]
  s_waitcnt lgkmcnt(10)
  v_mfma_f32_32x32x16_bf16 v[168:183], a[212:215], a[220:223], v[168:183]
  buffer_load_dwordx4 v17, s[84:87], s53 offen offset:3072 lds
  v_mfma_f32_32x32x16_bf16 v[200:215], a[212:215], a[224:227], v[200:215]
  ds_read_b128 v[156:159], v19 offset:12288
  v_mfma_f32_16x16x32_bf16 v[36:39], a[212:215], a[228:231], v[36:39]
  v_mfma_f32_32x32x16_bf16 v[184:199], a[216:219], a[220:223], v[184:199]
  v_mfma_f32_32x32x16_bf16 v[216:231], a[216:219], a[224:227], v[216:231]
  ds_read_b128 v[160:163], v20 offset:12288
  v_mfma_f32_16x16x32_bf16 v[40:43], a[216:219], a[228:231], v[40:43]
  s_add_u32 m0, s30, 4096
  s_waitcnt lgkmcnt(4)
  s_barrier
  v_mfma_f32_32x32x16_bf16 v[100:115], v[136:139], a[0:3], 0
  buffer_load_dwordx4 v14, s[88:91], s53 offen offset:0 lds
  v_fma_f32 v64, v64, s31, -v236
  v_fma_f32 v65, v65, s31, -v236
  v_mfma_f32_32x32x16_bf16 v[116:131], v[136:139], a[64:67], 0
  buffer_load_dwordx4 v15, s[88:91], s53 offen offset:1024 lds
  ds_read_b128 v[164:167], v21 offset:12288
  v_exp_f32 v64, v64
  v_mfma_f32_16x16x32_bf16 v[132:135], v[136:139], a[128:131], 0
  v_fma_f32 v66, v66, s31, -v236
  v_mfma_f32_32x32x16_bf16 v[100:115], v[140:143], a[4:7], v[100:115]
  buffer_load_dwordx4 v16, s[88:91], s53 offen offset:2048 lds
  v_exp_f32 v65, v65
  v_fma_f32 v67, v67, s31, -v236
  v_mfma_f32_32x32x16_bf16 v[116:131], v[140:143], a[68:71], v[116:131]
  s_waitcnt vmcnt(15)
  ds_read_b128 v[136:139], v18 offset:16384
  v_exp_f32 v66, v66
  v_fma_f32 v68, v68, s31, -v236
  v_mfma_f32_16x16x32_bf16 v[132:135], v[140:143], a[132:135], v[132:135]
  v_mfma_f32_32x32x16_bf16 v[100:115], v[144:147], a[8:11], v[100:115]
  buffer_load_dwordx4 v17, s[88:91], s53 offen offset:3072 lds
  v_exp_f32 v67, v67
  v_fma_f32 v69, v69, s31, -v236
  v_mfma_f32_32x32x16_bf16 v[116:131], v[144:147], a[72:75], v[116:131]
  ds_read_b128 v[140:143], v19 offset:16384
  v_exp_f32 v68, v68
  v_fma_f32 v70, v70, s31, -v236
  v_exp_f32 v69, v69
  v_mfma_f32_16x16x32_bf16 v[132:135], v[144:147], a[136:139], v[132:135]
  v_fma_f32 v71, v71, s31, -v236
  s_waitcnt lgkmcnt(6)
  v_mfma_f32_32x32x16_bf16 v[100:115], v[148:151], a[12:15], v[100:115]
  v_exp_f32 v70, v70
  v_exp_f32 v71, v71
  v_mfma_f32_32x32x16_bf16 v[116:131], v[148:151], a[76:79], v[116:131]
  ds_read_b128 v[144:147], v20 offset:16384
  v_add_f32 v239, v239, v64
  v_add_f32 v239, v239, v65
  v_mfma_f32_16x16x32_bf16 v[132:135], v[148:151], a[140:143], v[132:135]
  s_add_u32 m0, s30, 8192
  s_waitcnt lgkmcnt(6)
  v_mfma_f32_32x32x16_bf16 v[100:115], v[152:155], a[16:19], v[100:115]
  buffer_load_dwordx4 v14, s[92:95], s53 offen offset:0 lds
  v_cvt_pk_bf16_f32 v44, v64, v65
  v_add_f32 v239, v239, v66
  v_add_f32 v239, v239, v67
  v_mfma_f32_32x32x16_bf16 v[116:131], v[152:155], a[80:83], v[116:131]
  buffer_load_dwordx4 v15, s[92:95], s53 offen offset:1024 lds
  ds_read_b128 v[148:151], v21 offset:16384
  v_cvt_pk_bf16_f32 v45, v66, v67
  v_add_f32 v239, v239, v68
  v_mfma_f32_16x16x32_bf16 v[132:135], v[152:155], a[144:147], v[132:135]
  v_add_f32 v239, v239, v69
  s_waitcnt lgkmcnt(6)
  v_mfma_f32_32x32x16_bf16 v[100:115], v[156:159], a[20:23], v[100:115]
  buffer_load_dwordx4 v16, s[92:95], s53 offen offset:2048 lds
  v_cvt_pk_bf16_f32 v46, v68, v69
  v_add_f32 v239, v239, v70
  v_add_f32 v239, v239, v71
  v_mfma_f32_32x32x16_bf16 v[116:131], v[156:159], a[84:87], v[116:131]
  s_waitcnt vmcnt(15)
  ds_read_b128 v[152:155], v18 offset:20480
  v_cvt_pk_bf16_f32 v47, v70, v71
  v_fma_f32 v80, v80, s31, -v237
  v_fma_f32 v81, v81, s31, -v237
  v_mfma_f32_16x16x32_bf16 v[132:135], v[156:159], a[148:151], v[132:135]
  s_waitcnt lgkmcnt(6)
  v_mfma_f32_32x32x16_bf16 v[100:115], v[160:163], a[24:27], v[100:115]
  buffer_load_dwordx4 v17, s[92:95], s53 offen offset:3072 lds
  v_exp_f32 v80, v80
  v_fma_f32 v82, v82, s31, -v237
  v_mfma_f32_32x32x16_bf16 v[116:131], v[160:163], a[88:91], v[116:131]
  ds_read_b128 v[156:159], v19 offset:20480
  v_exp_f32 v81, v81
  v_fma_f32 v83, v83, s31, -v237
  v_exp_f32 v82, v82
  v_mfma_f32_16x16x32_bf16 v[132:135], v[160:163], a[152:155], v[132:135]
  v_fma_f32 v84, v84, s31, -v237
  s_waitcnt lgkmcnt(6)
  v_mfma_f32_32x32x16_bf16 v[100:115], v[164:167], a[28:31], v[100:115]
  v_exp_f32 v83, v83
  v_mfma_f32_32x32x16_bf16 v[116:131], v[164:167], a[92:95], v[116:131]
  ds_read_b128 v[160:163], v20 offset:20480
  v_fma_f32 v85, v85, s31, -v237
  v_exp_f32 v84, v84
  v_mfma_f32_16x16x32_bf16 v[132:135], v[164:167], a[156:159], v[132:135]
  s_add_u32 m0, s30, 12288
  s_waitcnt lgkmcnt(6)
  v_mfma_f32_32x32x16_bf16 v[100:115], v[136:139], a[32:35], v[100:115]
  buffer_load_dwordx4 v10, s[64:67], s56 offen offset:0 lds
  v_fma_f32 v86, v86, s31, -v237
  v_exp_f32 v85, v85
  v_mfma_f32_32x32x16_bf16 v[116:131], v[136:139], a[96:99], v[116:131]
  buffer_load_dwordx4 v11, s[64:67], s56 offen offset:1024 lds
  ds_read_b128 v[164:167], v21 offset:20480
  v_fma_f32 v87, v87, s31, -v237
  v_mfma_f32_16x16x32_bf16 v[132:135], v[136:139], a[160:163], v[132:135]
  s_waitcnt lgkmcnt(6)
  v_mfma_f32_32x32x16_bf16 v[100:115], v[140:143], a[36:39], v[100:115]
  buffer_load_dwordx4 v12, s[64:67], s56 offen offset:2048 lds
  v_exp_f32 v86, v86
  v_mfma_f32_32x32x16_bf16 v[116:131], v[140:143], a[100:103], v[116:131]
  s_waitcnt vmcnt(15)
  ds_read_b64_tr_b16 a[232:233], v22 offset:24576
  ds_read_b64_tr_b16 a[234:235], v22 offset:25600
  ds_read_b128 a[240:243], v26 offset:20480
  ds_read_b128 a[244:247], v26 offset:21504
  ds_read_b128 a[248:251], v30 offset:20480
  v_mfma_f32_16x16x32_bf16 v[132:135], v[140:143], a[164:167], v[132:135]
  ds_read_b64_tr_b16 a[236:237], v23 offset:24576
  s_waitcnt lgkmcnt(11)
  v_mfma_f32_32x32x16_bf16 v[100:115], v[144:147], a[40:43], v[100:115]
  buffer_load_dwordx4 v13, s[64:67], s56 offen offset:3072 lds
  ds_read_b64_tr_b16 a[238:239], v23 offset:25600
  v_exp_f32 v87, v87
  v_mfma_f32_32x32x16_bf16 v[116:131], v[144:147], a[104:107], v[116:131]
  v_add_f32 v240, v240, v80
  v_add_f32 v240, v240, v81
  v_cvt_pk_bf16_f32 v48, v80, v81
  v_add_f32 v240, v240, v82
  v_add_f32 v240, v240, v83
  v_cvt_pk_bf16_f32 v49, v82, v83
  v_mfma_f32_16x16x32_bf16 v[132:135], v[144:147], a[168:171], v[132:135]
  v_add_f32 v240, v240, v84
  s_waitcnt lgkmcnt(11)
  v_mfma_f32_32x32x16_bf16 v[100:115], v[148:151], a[44:47], v[100:115]
  v_add_f32 v240, v240, v85
  v_cvt_pk_bf16_f32 v50, v84, v85
  v_add_f32 v240, v240, v86
  v_add_f32 v240, v240, v87
  v_cvt_pk_bf16_f32 v51, v86, v87
  v_fma_f32 v72, v72, s31, -v236
  v_mfma_f32_32x32x16_bf16 v[116:131], v[148:151], a[108:111], v[116:131]
  ds_read_b64_tr_b16 a[192:193], v22 offset:26624
  ds_read_b64_tr_b16 a[194:195], v22 offset:27648
  ds_read_b128 a[200:203], v26 offset:22528
  ds_read_b128 a[204:207], v26 offset:23552
  s_waitcnt lgkmcnt(13)
  ds_read_b128 a[208:211], v30 offset:20992
  v_mfma_f32_16x16x32_bf16 v[132:135], v[148:151], a[172:175], v[132:135]
  s_add_u32 m0, s30, 16384
  v_mfma_f32_32x32x16_bf16 v[100:115], v[152:155], a[48:51], v[100:115]
  buffer_load_dwordx4 v10, s[68:71], s56 offen offset:0 lds
  ds_read_b64_tr_b16 a[196:197], v23 offset:26624
  s_waitcnt lgkmcnt(13)
  ds_read_b64_tr_b16 a[198:199], v23 offset:27648
  v_mfma_f32_32x32x16_bf16 v[116:131], v[152:155], a[112:115], v[116:131]
  buffer_load_dwordx4 v11, s[68:71], s56 offen offset:1024 lds
  v_fma_f32 v73, v73, s31, -v236
  v_exp_f32 v72, v72
  v_mfma_f32_16x16x32_bf16 v[132:135], v[152:155], a[176:179], v[132:135]
  v_fma_f32 v74, v74, s31, -v236
  v_mfma_f32_32x32x16_bf16 v[100:115], v[156:159], a[52:55], v[100:115]
  buffer_load_dwordx4 v12, s[68:71], s56 offen offset:2048 lds
  v_exp_f32 v73, v73
  v_fma_f32 v75, v75, s31, -v236
  v_mfma_f32_32x32x16_bf16 v[116:131], v[156:159], a[116:119], v[116:131]
  s_waitcnt vmcnt(15)
  ds_read_b64_tr_b16 a[212:213], v22 offset:0
  s_waitcnt lgkmcnt(13)
  ds_read_b64_tr_b16 a[214:215], v22 offset:1024
  ds_read_b128 a[220:223], v27 offset:20480
  s_waitcnt lgkmcnt(13)
  ds_read_b128 a[224:227], v27 offset:21504
  v_mfma_f32_16x16x32_bf16 v[132:135], v[156:159], a[180:183], v[132:135]
  ds_read_b128 a[228:231], v31 offset:20480
  v_mfma_f32_32x32x16_bf16 v[100:115], v[160:163], a[56:59], v[100:115]
  buffer_load_dwordx4 v13, s[68:71], s56 offen offset:3072 lds
  s_waitcnt lgkmcnt(13)
  ds_read_b64_tr_b16 a[216:217], v23 offset:0
  ds_read_b64_tr_b16 a[218:219], v23 offset:1024
  v_mfma_f32_32x32x16_bf16 v[116:131], v[160:163], a[120:123], v[116:131]
  v_exp_f32 v74, v74
  v_fma_f32 v76, v76, s31, -v236
  v_exp_f32 v75, v75
  v_fma_f32 v77, v77, s31, -v236
  v_mfma_f32_16x16x32_bf16 v[132:135], v[160:163], a[184:187], v[132:135]
  v_mfma_f32_32x32x16_bf16 v[100:115], v[164:167], a[60:63], v[100:115]
  v_exp_f32 v76, v76
  v_fma_f32 v78, v78, s31, -v236
  v_exp_f32 v77, v77
  v_fma_f32 v79, v79, s31, -v236
  v_mfma_f32_32x32x16_bf16 v[116:131], v[164:167], a[124:127], v[116:131]
  v_exp_f32 v78, v78
  v_exp_f32 v79, v79
  v_add_f32 v239, v239, v72
  v_add_f32 v239, v239, v73
  v_mfma_f32_16x16x32_bf16 v[132:135], v[164:167], a[188:191], v[132:135]
  s_add_u32 m0, s30, 20480
  s_waitcnt lgkmcnt(14)
  v_mfma_f32_32x32x16_bf16 v[168:183], a[232:235], a[240:243], v[168:183]
  buffer_load_dwordx4 v10, s[72:75], s56 offen offset:0 lds
  v_cvt_pk_bf16_f32 v52, v72, v73
  v_add_f32 v239, v239, v74
  v_add_f32 v239, v239, v75
  v_mfma_f32_32x32x16_bf16 v[200:215], a[232:235], a[244:247], v[200:215]
  buffer_load_dwordx4 v11, s[72:75], s56 offen offset:1024 lds
  v_cvt_pk_bf16_f32 v53, v74, v75
  v_add_f32 v239, v239, v76
  v_add_f32 v239, v239, v77
  v_mfma_f32_16x16x32_bf16 v[36:39], a[232:235], a[248:251], v[36:39]
  v_cvt_pk_bf16_f32 v54, v76, v77
  v_add_f32 v239, v239, v78
  v_mfma_f32_32x32x16_bf16 v[184:199], a[236:239], a[240:243], v[184:199]
  buffer_load_dwordx4 v12, s[72:75], s56 offen offset:2048 lds
  v_add_f32 v239, v239, v79
  v_cvt_pk_bf16_f32 v55, v78, v79
  v_fma_f32 v88, v88, s31, -v237
  v_mfma_f32_32x32x16_bf16 v[216:231], a[236:239], a[244:247], v[216:231]
  v_fma_f32 v89, v89, s31, -v237
  v_exp_f32 v88, v88
  v_mfma_f32_16x16x32_bf16 v[40:43], a[236:239], a[248:251], v[40:43]
  ds_read_b64_tr_b16 a[232:233], v22 offset:2048
  s_waitcnt lgkmcnt(8)
  v_mfma_f32_32x32x16_bf16 v[168:183], a[192:195], a[200:203], v[168:183]
  buffer_load_dwordx4 v13, s[72:75], s56 offen offset:3072 lds
  ds_read_b64_tr_b16 a[234:235], v22 offset:3072
  ds_read_b128 a[240:243], v27 offset:22528
  ds_read_b128 a[244:247], v27 offset:23552
  v_mfma_f32_32x32x16_bf16 v[200:215], a[192:195], a[204:207], v[200:215]
  ds_read_b128 a[248:251], v31 offset:20992
  ds_read_b64_tr_b16 a[236:237], v23 offset:2048
  ds_read_b64_tr_b16 a[238:239], v23 offset:3072
  v_fma_f32 v90, v90, s31, -v237
  v_exp_f32 v89, v89
  v_mfma_f32_16x16x32_bf16 v[36:39], a[192:195], a[208:211], v[36:39]
  v_fma_f32 v91, v91, s31, -v237
  v_mfma_f32_32x32x16_bf16 v[184:199], a[196:199], a[200:203], v[184:199]
  v_exp_f32 v90, v90
  v_fma_f32 v92, v92, s31, -v237
  v_exp_f32 v91, v91
  v_fma_f32 v93, v93, s31, -v237
  v_mfma_f32_32x32x16_bf16 v[216:231], a[196:199], a[204:207], v[216:231]
  v_exp_f32 v92, v92
  v_fma_f32 v94, v94, s31, -v237
  v_mfma_f32_16x16x32_bf16 v[40:43], a[196:199], a[208:211], v[40:43]
  s_add_u32 m0, s30, 24576
  s_waitcnt vmcnt(16) lgkmcnt(7)
  v_mfma_f32_32x32x16_bf16 v[168:183], a[212:215], a[220:223], v[168:183]
  buffer_load_dwordx4 v10, s[76:79], s56 offen offset:0 lds
  ds_read_b64_tr_b16 a[192:193], v22 offset:4096
  ds_read_b64_tr_b16 a[194:195], v22 offset:5120
  ds_read_b128 a[200:203], v28 offset:20480
  v_mfma_f32_32x32x16_bf16 v[200:215], a[212:215], a[224:227], v[200:215]
  buffer_load_dwordx4 v11, s[76:79], s56 offen offset:1024 lds
  ds_read_b128 a[204:207], v28 offset:21504
  ds_read_b128 a[208:211], v32 offset:20480
  ds_read_b64_tr_b16 a[196:197], v23 offset:4096
  v_mfma_f32_16x16x32_bf16 v[36:39], a[212:215], a[228:231], v[36:39]
  ds_read_b64_tr_b16 a[198:199], v23 offset:5120
  v_mfma_f32_32x32x16_bf16 v[184:199], a[216:219], a[220:223], v[184:199]
  buffer_load_dwordx4 v12, s[76:79], s56 offen offset:2048 lds
  v_exp_f32 v93, v93
  v_fma_f32 v95, v95, s31, -v237
  v_mfma_f32_32x32x16_bf16 v[216:231], a[216:219], a[224:227], v[216:231]
  v_exp_f32 v94, v94
  v_exp_f32 v95, v95
  v_add_f32 v240, v240, v88
  v_add_f32 v240, v240, v89
  v_mfma_f32_16x16x32_bf16 v[40:43], a[216:219], a[228:231], v[40:43]
  ds_read_b64_tr_b16 a[212:213], v22 offset:6144
  s_waitcnt lgkmcnt(8)
  v_mfma_f32_32x32x16_bf16 v[168:183], a[232:235], a[240:243], v[168:183]
  buffer_load_dwordx4 v13, s[76:79], s56 offen offset:3072 lds
  ds_read_b64_tr_b16 a[214:215], v22 offset:7168
  ds_read_b128 a[220:223], v28 offset:22528
  ds_read_b128 a[224:227], v28 offset:23552
  v_mfma_f32_32x32x16_bf16 v[200:215], a[232:235], a[244:247], v[200:215]
  ds_read_b128 a[228:231], v32 offset:20992
  ds_read_b64_tr_b16 a[216:217], v23 offset:6144
  ds_read_b64_tr_b16 a[218:219], v23 offset:7168
  v_cvt_pk_bf16_f32 v4, v88, v89
  v_add_f32 v240, v240, v90
  v_add_f32 v240, v240, v91
  v_mfma_f32_16x16x32_bf16 v[36:39], a[232:235], a[248:251], v[36:39]
  v_cvt_pk_bf16_f32 v5, v90, v91
  v_add_f32 v240, v240, v92
  v_mfma_f32_32x32x16_bf16 v[184:199], a[236:239], a[240:243], v[184:199]
  v_add_f32 v240, v240, v93
  v_cvt_pk_bf16_f32 v6, v92, v93
  v_add_f32 v240, v240, v94
  v_add_f32 v240, v240, v95
  v_cvt_pk_bf16_f32 v7, v94, v95
  v_fma_f32 v96, v96, s31, -v238
  v_mfma_f32_32x32x16_bf16 v[216:231], a[236:239], a[244:247], v[216:231]
  v_fma_f32 v97, v97, s31, -v238
  v_exp_f32 v96, v96
  v_fma_f32 v98, v98, s31, -v238
  v_mfma_f32_16x16x32_bf16 v[40:43], a[236:239], a[248:251], v[40:43]
  s_add_u32 m0, s30, 0
  s_waitcnt vmcnt(16) lgkmcnt(7)
  v_mfma_f32_32x32x16_bf16 v[168:183], a[192:195], a[200:203], v[168:183]
  buffer_load_dwordx4 v14, s[80:83], s54 offen offset:0 lds
  ds_read_b64_tr_b16 a[232:233], v22 offset:8192
  ds_read_b64_tr_b16 a[234:235], v22 offset:9216
  ds_read_b128 a[240:243], v29 offset:20480
  v_mfma_f32_32x32x16_bf16 v[200:215], a[192:195], a[204:207], v[200:215]
  buffer_load_dwordx4 v15, s[80:83], s54 offen offset:1024 lds
  ds_read_b128 a[244:247], v29 offset:21504
  ds_read_b128 a[248:251], v33 offset:20480
  ds_read_b64_tr_b16 a[236:237], v23 offset:8192
  v_mfma_f32_16x16x32_bf16 v[36:39], a[192:195], a[208:211], v[36:39]
  ds_read_b64_tr_b16 a[238:239], v23 offset:9216
  v_mfma_f32_32x32x16_bf16 v[184:199], a[196:199], a[200:203], v[184:199]
  buffer_load_dwordx4 v16, s[80:83], s54 offen offset:2048 lds
  v_exp_f32 v97, v97
  v_fma_f32 v99, v99, s31, -v238
  v_mfma_f32_32x32x16_bf16 v[216:231], a[196:199], a[204:207], v[216:231]
  v_exp_f32 v98, v98
  v_exp_f32 v99, v99
  v_add_f32 v241, v241, v96
  v_add_f32 v241, v241, v97
  v_mfma_f32_16x16x32_bf16 v[40:43], a[196:199], a[208:211], v[40:43]
  ds_read_b64_tr_b16 a[192:193], v22 offset:10240
  s_waitcnt lgkmcnt(8)
  v_mfma_f32_32x32x16_bf16 v[168:183], a[212:215], a[220:223], v[168:183]
  buffer_load_dwordx4 v17, s[80:83], s54 offen offset:3072 lds
  ds_read_b64_tr_b16 a[194:195], v22 offset:11264
  ds_read_b128 a[200:203], v29 offset:22528
  ds_read_b128 a[204:207], v29 offset:23552
  v_mfma_f32_32x32x16_bf16 v[200:215], a[212:215], a[224:227], v[200:215]
  ds_read_b128 a[208:211], v33 offset:20992
  ds_read_b64_tr_b16 a[196:197], v23 offset:10240
  ds_read_b64_tr_b16 a[198:199], v23 offset:11264
  s_waitcnt vmcnt(16)
  ds_read_b128 v[136:139], v18 offset:12288
  s_waitcnt lgkmcnt(13)
  ds_read_b128 v[140:143], v19 offset:12288
  v_mfma_f32_16x16x32_bf16 v[36:39], a[212:215], a[228:231], v[36:39]
  v_cvt_pk_bf16_f32 v8, v96, v97
  v_add_f32 v241, v241, v98
  v_mfma_f32_32x32x16_bf16 v[184:199], a[216:219], a[220:223], v[184:199]
  v_add_f32 v241, v241, v99
  v_cvt_pk_bf16_f32 v9, v98, v99
  ds_write_b128 v24, v[44:47] offset:0
  s_waitcnt lgkmcnt(13)
  ds_write_b128 v24, v[48:51] offset:1024
  ds_write_b128 v24, v[52:55] offset:2048
  v_mfma_f32_32x32x16_bf16 v[216:231], a[216:219], a[224:227], v[216:231]
  s_waitcnt lgkmcnt(13)
  ds_read_b128 v[144:147], v20 offset:12288
  ds_write_b128 v24, v[4:7] offset:3072
  s_waitcnt lgkmcnt(13)
  ds_write_b64 v25, v[8:9] offset:0
  v_mfma_f32_16x16x32_bf16 v[40:43], a[216:219], a[228:231], v[40:43]
  s_add_u32 m0, s30, 4096
  v_mfma_f32_32x32x16_bf16 v[168:183], a[232:235], a[240:243], v[168:183]
  buffer_load_dwordx4 v14, s[84:87], s54 offen offset:0 lds
  v_mfma_f32_32x32x16_bf16 v[200:215], a[232:235], a[244:247], v[200:215]
  buffer_load_dwordx4 v15, s[84:87], s54 offen offset:1024 lds
  ds_read_b128 v[148:151], v21 offset:12288
  v_mfma_f32_16x16x32_bf16 v[36:39], a[232:235], a[248:251], v[36:39]
  v_mfma_f32_32x32x16_bf16 v[184:199], a[236:239], a[240:243], v[184:199]
  buffer_load_dwordx4 v16, s[84:87], s54 offen offset:2048 lds
  v_mfma_f32_32x32x16_bf16 v[216:231], a[236:239], a[244:247], v[216:231]
  s_waitcnt vmcnt(15) lgkmcnt(13)
  ds_read_b128 v[152:155], v18 offset:16384
  v_mfma_f32_16x16x32_bf16 v[40:43], a[236:239], a[248:251], v[40:43]
  s_waitcnt lgkmcnt(10)
  v_mfma_f32_32x32x16_bf16 v[168:183], a[192:195], a[200:203], v[168:183]
  buffer_load_dwordx4 v17, s[84:87], s54 offen offset:3072 lds
  v_mfma_f32_32x32x16_bf16 v[200:215], a[192:195], a[204:207], v[200:215]
  ds_read_b128 v[156:159], v19 offset:16384
  v_mfma_f32_16x16x32_bf16 v[36:39], a[192:195], a[208:211], v[36:39]
  v_mfma_f32_32x32x16_bf16 v[184:199], a[196:199], a[200:203], v[184:199]
  v_mfma_f32_32x32x16_bf16 v[216:231], a[196:199], a[204:207], v[216:231]
  ds_read_b128 v[160:163], v20 offset:16384
  v_mfma_f32_16x16x32_bf16 v[40:43], a[196:199], a[208:211], v[40:43]
  s_add_u32 m0, s30, 8192
  s_waitcnt lgkmcnt(4)
  s_barrier
  v_mfma_f32_32x32x16_bf16 v[64:79], v[136:139], a[0:3], 0
  buffer_load_dwordx4 v14, s[88:91], s54 offen offset:0 lds
  v_fma_f32 v100, v100, s31, -v236
  v_fma_f32 v101, v101, s31, -v236
  v_mfma_f32_32x32x16_bf16 v[80:95], v[136:139], a[64:67], 0
  buffer_load_dwordx4 v15, s[88:91], s54 offen offset:1024 lds
  ds_read_b128 v[164:167], v21 offset:16384
  v_exp_f32 v100, v100
  v_mfma_f32_16x16x32_bf16 v[96:99], v[136:139], a[128:131], 0
  v_fma_f32 v102, v102, s31, -v236
  v_mfma_f32_32x32x16_bf16 v[64:79], v[140:143], a[4:7], v[64:79]
  buffer_load_dwordx4 v16, s[88:91], s54 offen offset:2048 lds
  v_exp_f32 v101, v101
  v_fma_f32 v103, v103, s31, -v236
  v_mfma_f32_32x32x16_bf16 v[80:95], v[140:143], a[68:71], v[80:95]
  s_waitcnt vmcnt(15)
  ds_read_b128 v[136:139], v18 offset:20480
  v_exp_f32 v102, v102
  v_fma_f32 v104, v104, s31, -v236
  v_mfma_f32_16x16x32_bf16 v[96:99], v[140:143], a[132:135], v[96:99]
  v_mfma_f32_32x32x16_bf16 v[64:79], v[144:147], a[8:11], v[64:79]
  buffer_load_dwordx4 v17, s[88:91], s54 offen offset:3072 lds
  v_exp_f32 v103, v103
  v_fma_f32 v105, v105, s31, -v236
  v_mfma_f32_32x32x16_bf16 v[80:95], v[144:147], a[72:75], v[80:95]
  ds_read_b128 v[140:143], v19 offset:20480
  v_exp_f32 v104, v104
  v_fma_f32 v106, v106, s31, -v236
  v_exp_f32 v105, v105
  v_mfma_f32_16x16x32_bf16 v[96:99], v[144:147], a[136:139], v[96:99]
  v_fma_f32 v107, v107, s31, -v236
  s_waitcnt lgkmcnt(6)
  v_mfma_f32_32x32x16_bf16 v[64:79], v[148:151], a[12:15], v[64:79]
  v_exp_f32 v106, v106
  v_exp_f32 v107, v107
  v_mfma_f32_32x32x16_bf16 v[80:95], v[148:151], a[76:79], v[80:95]
  ds_read_b128 v[144:147], v20 offset:20480
  v_add_f32 v239, v239, v100
  v_add_f32 v239, v239, v101
  v_mfma_f32_16x16x32_bf16 v[96:99], v[148:151], a[140:143], v[96:99]
  s_add_u32 m0, s30, 12288
  s_waitcnt lgkmcnt(6)
  v_mfma_f32_32x32x16_bf16 v[64:79], v[152:155], a[16:19], v[64:79]
  buffer_load_dwordx4 v14, s[92:95], s54 offen offset:0 lds
  v_cvt_pk_bf16_f32 v44, v100, v101
  v_add_f32 v239, v239, v102
  v_add_f32 v239, v239, v103
  v_mfma_f32_32x32x16_bf16 v[80:95], v[152:155], a[80:83], v[80:95]
  buffer_load_dwordx4 v15, s[92:95], s54 offen offset:1024 lds
  ds_read_b128 v[148:151], v21 offset:20480
  v_cvt_pk_bf16_f32 v45, v102, v103
  v_add_f32 v239, v239, v104
  v_mfma_f32_16x16x32_bf16 v[96:99], v[152:155], a[144:147], v[96:99]
  v_add_f32 v239, v239, v105
  s_waitcnt lgkmcnt(6)
  v_mfma_f32_32x32x16_bf16 v[64:79], v[156:159], a[20:23], v[64:79]
  buffer_load_dwordx4 v16, s[92:95], s54 offen offset:2048 lds
  v_cvt_pk_bf16_f32 v46, v104, v105
  v_add_f32 v239, v239, v106
  v_add_f32 v239, v239, v107
  v_mfma_f32_32x32x16_bf16 v[80:95], v[156:159], a[84:87], v[80:95]
  s_waitcnt vmcnt(15)
  ds_read_b128 v[152:155], v18 offset:24576
  v_cvt_pk_bf16_f32 v47, v106, v107
  v_fma_f32 v116, v116, s31, -v237
  v_fma_f32 v117, v117, s31, -v237
  v_mfma_f32_16x16x32_bf16 v[96:99], v[156:159], a[148:151], v[96:99]
  s_waitcnt lgkmcnt(6)
  v_mfma_f32_32x32x16_bf16 v[64:79], v[160:163], a[24:27], v[64:79]
  buffer_load_dwordx4 v17, s[92:95], s54 offen offset:3072 lds
  v_exp_f32 v116, v116
  v_fma_f32 v118, v118, s31, -v237
  v_mfma_f32_32x32x16_bf16 v[80:95], v[160:163], a[88:91], v[80:95]
  ds_read_b128 v[156:159], v19 offset:24576
  v_exp_f32 v117, v117
  v_fma_f32 v119, v119, s31, -v237
  v_exp_f32 v118, v118
  v_mfma_f32_16x16x32_bf16 v[96:99], v[160:163], a[152:155], v[96:99]
  v_fma_f32 v120, v120, s31, -v237
  s_waitcnt lgkmcnt(6)
  v_mfma_f32_32x32x16_bf16 v[64:79], v[164:167], a[28:31], v[64:79]
  v_exp_f32 v119, v119
  v_mfma_f32_32x32x16_bf16 v[80:95], v[164:167], a[92:95], v[80:95]
  ds_read_b128 v[160:163], v20 offset:24576
  v_fma_f32 v121, v121, s31, -v237
  v_exp_f32 v120, v120
  v_mfma_f32_16x16x32_bf16 v[96:99], v[164:167], a[156:159], v[96:99]
  s_add_u32 m0, s30, 16384
  s_waitcnt lgkmcnt(6)
  v_mfma_f32_32x32x16_bf16 v[64:79], v[136:139], a[32:35], v[64:79]
  buffer_load_dwordx4 v10, s[64:67], s57 offen offset:0 lds
  v_fma_f32 v122, v122, s31, -v237
  v_exp_f32 v121, v121
  v_mfma_f32_32x32x16_bf16 v[80:95], v[136:139], a[96:99], v[80:95]
  buffer_load_dwordx4 v11, s[64:67], s57 offen offset:1024 lds
  ds_read_b128 v[164:167], v21 offset:24576
  v_fma_f32 v123, v123, s31, -v237
  v_mfma_f32_16x16x32_bf16 v[96:99], v[136:139], a[160:163], v[96:99]
  s_waitcnt lgkmcnt(6)
  v_mfma_f32_32x32x16_bf16 v[64:79], v[140:143], a[36:39], v[64:79]
  buffer_load_dwordx4 v12, s[64:67], s57 offen offset:2048 lds
  v_exp_f32 v122, v122
  v_mfma_f32_32x32x16_bf16 v[80:95], v[140:143], a[100:103], v[80:95]
  s_waitcnt vmcnt(15)
  ds_read_b64_tr_b16 a[212:213], v22 offset:0
  ds_read_b64_tr_b16 a[214:215], v22 offset:1024
  ds_read_b128 a[220:223], v26 offset:0
  ds_read_b128 a[224:227], v26 offset:1024
  ds_read_b128 a[228:231], v30 offset:0
  v_mfma_f32_16x16x32_bf16 v[96:99], v[140:143], a[164:167], v[96:99]
  ds_read_b64_tr_b16 a[216:217], v23 offset:0
  s_waitcnt lgkmcnt(11)
  v_mfma_f32_32x32x16_bf16 v[64:79], v[144:147], a[40:43], v[64:79]
  buffer_load_dwordx4 v13, s[64:67], s57 offen offset:3072 lds
  ds_read_b64_tr_b16 a[218:219], v23 offset:1024
  v_exp_f32 v123, v123
  v_mfma_f32_32x32x16_bf16 v[80:95], v[144:147], a[104:107], v[80:95]
  v_add_f32 v240, v240, v116
  v_add_f32 v240, v240, v117
  v_cvt_pk_bf16_f32 v48, v116, v117
  v_add_f32 v240, v240, v118
  v_add_f32 v240, v240, v119
  v_cvt_pk_bf16_f32 v49, v118, v119
  v_mfma_f32_16x16x32_bf16 v[96:99], v[144:147], a[168:171], v[96:99]
  v_add_f32 v240, v240, v120
  s_waitcnt lgkmcnt(11)
  v_mfma_f32_32x32x16_bf16 v[64:79], v[148:151], a[44:47], v[64:79]
  v_add_f32 v240, v240, v121
  v_cvt_pk_bf16_f32 v50, v120, v121
  v_add_f32 v240, v240, v122
  v_add_f32 v240, v240, v123
  v_cvt_pk_bf16_f32 v51, v122, v123
  v_fma_f32 v108, v108, s31, -v236
  v_mfma_f32_32x32x16_bf16 v[80:95], v[148:151], a[108:111], v[80:95]
  ds_read_b64_tr_b16 a[232:233], v22 offset:2048
  ds_read_b64_tr_b16 a[234:235], v22 offset:3072
  ds_read_b128 a[240:243], v26 offset:2048
  ds_read_b128 a[244:247], v26 offset:3072
  s_waitcnt lgkmcnt(13)
  ds_read_b128 a[248:251], v30 offset:512
  v_mfma_f32_16x16x32_bf16 v[96:99], v[148:151], a[172:175], v[96:99]
  s_add_u32 m0, s30, 20480
  v_mfma_f32_32x32x16_bf16 v[64:79], v[152:155], a[48:51], v[64:79]
  buffer_load_dwordx4 v10, s[68:71], s57 offen offset:0 lds
  ds_read_b64_tr_b16 a[236:237], v23 offset:2048
  s_waitcnt lgkmcnt(13)
  ds_read_b64_tr_b16 a[238:239], v23 offset:3072
  v_mfma_f32_32x32x16_bf16 v[80:95], v[152:155], a[112:115], v[80:95]
  buffer_load_dwordx4 v11, s[68:71], s57 offen offset:1024 lds
  v_fma_f32 v109, v109, s31, -v236
  v_exp_f32 v108, v108
  v_mfma_f32_16x16x32_bf16 v[96:99], v[152:155], a[176:179], v[96:99]
  v_fma_f32 v110, v110, s31, -v236
  v_mfma_f32_32x32x16_bf16 v[64:79], v[156:159], a[52:55], v[64:79]
  buffer_load_dwordx4 v12, s[68:71], s57 offen offset:2048 lds
  v_exp_f32 v109, v109
  v_fma_f32 v111, v111, s31, -v236
  v_mfma_f32_32x32x16_bf16 v[80:95], v[156:159], a[116:119], v[80:95]
  s_waitcnt vmcnt(15)
  ds_read_b64_tr_b16 a[192:193], v22 offset:4096
  s_waitcnt lgkmcnt(13)
  ds_read_b64_tr_b16 a[194:195], v22 offset:5120
  ds_read_b128 a[200:203], v27 offset:0
  s_waitcnt lgkmcnt(13)
  ds_read_b128 a[204:207], v27 offset:1024
  v_mfma_f32_16x16x32_bf16 v[96:99], v[156:159], a[180:183], v[96:99]
  ds_read_b128 a[208:211], v31 offset:0
  v_mfma_f32_32x32x16_bf16 v[64:79], v[160:163], a[56:59], v[64:79]
  buffer_load_dwordx4 v13, s[68:71], s57 offen offset:3072 lds
  s_waitcnt lgkmcnt(13)
  ds_read_b64_tr_b16 a[196:197], v23 offset:4096
  ds_read_b64_tr_b16 a[198:199], v23 offset:5120
  v_mfma_f32_32x32x16_bf16 v[80:95], v[160:163], a[120:123], v[80:95]
  v_exp_f32 v110, v110
  v_fma_f32 v112, v112, s31, -v236
  v_exp_f32 v111, v111
  v_fma_f32 v113, v113, s31, -v236
  v_mfma_f32_16x16x32_bf16 v[96:99], v[160:163], a[184:187], v[96:99]
  v_mfma_f32_32x32x16_bf16 v[64:79], v[164:167], a[60:63], v[64:79]
  v_exp_f32 v112, v112
  v_fma_f32 v114, v114, s31, -v236
  v_exp_f32 v113, v113
  v_fma_f32 v115, v115, s31, -v236
  v_mfma_f32_32x32x16_bf16 v[80:95], v[164:167], a[124:127], v[80:95]
  v_exp_f32 v114, v114
  v_exp_f32 v115, v115
  v_add_f32 v239, v239, v108
  v_add_f32 v239, v239, v109
  v_mfma_f32_16x16x32_bf16 v[96:99], v[164:167], a[188:191], v[96:99]
  s_add_u32 m0, s30, 24576
  s_waitcnt lgkmcnt(14)
  v_mfma_f32_32x32x16_bf16 v[168:183], a[212:215], a[220:223], v[168:183]
  buffer_load_dwordx4 v10, s[72:75], s57 offen offset:0 lds
  v_cvt_pk_bf16_f32 v52, v108, v109
  v_add_f32 v239, v239, v110
  v_add_f32 v239, v239, v111
  v_mfma_f32_32x32x16_bf16 v[200:215], a[212:215], a[224:227], v[200:215]
  buffer_load_dwordx4 v11, s[72:75], s57 offen offset:1024 lds
  v_cvt_pk_bf16_f32 v53, v110, v111
  v_add_f32 v239, v239, v112
  v_add_f32 v239, v239, v113
  v_mfma_f32_16x16x32_bf16 v[36:39], a[212:215], a[228:231], v[36:39]
  v_cvt_pk_bf16_f32 v54, v112, v113
  v_add_f32 v239, v239, v114
  v_mfma_f32_32x32x16_bf16 v[184:199], a[216:219], a[220:223], v[184:199]
  buffer_load_dwordx4 v12, s[72:75], s57 offen offset:2048 lds
  v_add_f32 v239, v239, v115
  v_cvt_pk_bf16_f32 v55, v114, v115
  v_fma_f32 v124, v124, s31, -v237
  v_mfma_f32_32x32x16_bf16 v[216:231], a[216:219], a[224:227], v[216:231]
  v_fma_f32 v125, v125, s31, -v237
  v_exp_f32 v124, v124
  v_mfma_f32_16x16x32_bf16 v[40:43], a[216:219], a[228:231], v[40:43]
  ds_read_b64_tr_b16 a[212:213], v22 offset:6144
  s_waitcnt lgkmcnt(8)
  v_mfma_f32_32x32x16_bf16 v[168:183], a[232:235], a[240:243], v[168:183]
  buffer_load_dwordx4 v13, s[72:75], s57 offen offset:3072 lds
  ds_read_b64_tr_b16 a[214:215], v22 offset:7168
  ds_read_b128 a[220:223], v27 offset:2048
  ds_read_b128 a[224:227], v27 offset:3072
  v_mfma_f32_32x32x16_bf16 v[200:215], a[232:235], a[244:247], v[200:215]
  ds_read_b128 a[228:231], v31 offset:512
  ds_read_b64_tr_b16 a[216:217], v23 offset:6144
  ds_read_b64_tr_b16 a[218:219], v23 offset:7168
  v_fma_f32 v126, v126, s31, -v237
  v_exp_f32 v125, v125
  v_mfma_f32_16x16x32_bf16 v[36:39], a[232:235], a[248:251], v[36:39]
  v_fma_f32 v127, v127, s31, -v237
  v_mfma_f32_32x32x16_bf16 v[184:199], a[236:239], a[240:243], v[184:199]
  v_exp_f32 v126, v126
  v_fma_f32 v128, v128, s31, -v237
  v_exp_f32 v127, v127
  v_fma_f32 v129, v129, s31, -v237
  v_mfma_f32_32x32x16_bf16 v[216:231], a[236:239], a[244:247], v[216:231]
  v_exp_f32 v128, v128
  v_fma_f32 v130, v130, s31, -v237
  v_mfma_f32_16x16x32_bf16 v[40:43], a[236:239], a[248:251], v[40:43]
  s_add_u32 m0, s30, 0
  s_waitcnt vmcnt(16) lgkmcnt(7)
  v_mfma_f32_32x32x16_bf16 v[168:183], a[192:195], a[200:203], v[168:183]
  buffer_load_dwordx4 v10, s[76:79], s57 offen offset:0 lds
  ds_read_b64_tr_b16 a[232:233], v22 offset:8192
  ds_read_b64_tr_b16 a[234:235], v22 offset:9216
  ds_read_b128 a[240:243], v28 offset:0
  v_mfma_f32_32x32x16_bf16 v[200:215], a[192:195], a[204:207], v[200:215]
  buffer_load_dwordx4 v11, s[76:79], s57 offen offset:1024 lds
  ds_read_b128 a[244:247], v28 offset:1024
  ds_read_b128 a[248:251], v32 offset:0
  ds_read_b64_tr_b16 a[236:237], v23 offset:8192
  v_mfma_f32_16x16x32_bf16 v[36:39], a[192:195], a[208:211], v[36:39]
  ds_read_b64_tr_b16 a[238:239], v23 offset:9216
  v_mfma_f32_32x32x16_bf16 v[184:199], a[196:199], a[200:203], v[184:199]
  buffer_load_dwordx4 v12, s[76:79], s57 offen offset:2048 lds
  v_exp_f32 v129, v129
  v_fma_f32 v131, v131, s31, -v237
  v_mfma_f32_32x32x16_bf16 v[216:231], a[196:199], a[204:207], v[216:231]
  v_exp_f32 v130, v130
  v_exp_f32 v131, v131
  v_add_f32 v240, v240, v124
  v_add_f32 v240, v240, v125
  v_mfma_f32_16x16x32_bf16 v[40:43], a[196:199], a[208:211], v[40:43]
  ds_read_b64_tr_b16 a[192:193], v22 offset:10240
  s_waitcnt lgkmcnt(8)
  v_mfma_f32_32x32x16_bf16 v[168:183], a[212:215], a[220:223], v[168:183]
  buffer_load_dwordx4 v13, s[76:79], s57 offen offset:3072 lds
  ds_read_b64_tr_b16 a[194:195], v22 offset:11264
  ds_read_b128 a[200:203], v28 offset:2048
  ds_read_b128 a[204:207], v28 offset:3072
  v_mfma_f32_32x32x16_bf16 v[200:215], a[212:215], a[224:227], v[200:215]
  ds_read_b128 a[208:211], v32 offset:512
  ds_read_b64_tr_b16 a[196:197], v23 offset:10240
  ds_read_b64_tr_b16 a[198:199], v23 offset:11264
  v_cvt_pk_bf16_f32 v4, v124, v125
  v_add_f32 v240, v240, v126
  v_add_f32 v240, v240, v127
  v_mfma_f32_16x16x32_bf16 v[36:39], a[212:215], a[228:231], v[36:39]
  v_cvt_pk_bf16_f32 v5, v126, v127
  v_add_f32 v240, v240, v128
  v_mfma_f32_32x32x16_bf16 v[184:199], a[216:219], a[220:223], v[184:199]
  v_add_f32 v240, v240, v129
  v_cvt_pk_bf16_f32 v6, v128, v129
  v_add_f32 v240, v240, v130
  v_add_f32 v240, v240, v131
  v_cvt_pk_bf16_f32 v7, v130, v131
  v_fma_f32 v132, v132, s31, -v238
  v_mfma_f32_32x32x16_bf16 v[216:231], a[216:219], a[224:227], v[216:231]
  v_fma_f32 v133, v133, s31, -v238
  v_exp_f32 v132, v132
  v_fma_f32 v134, v134, s31, -v238
  v_mfma_f32_16x16x32_bf16 v[40:43], a[216:219], a[228:231], v[40:43]
  s_add_u32 m0, s30, 4096
  s_waitcnt vmcnt(16) lgkmcnt(7)
  v_mfma_f32_32x32x16_bf16 v[168:183], a[232:235], a[240:243], v[168:183]
  buffer_load_dwordx4 v14, s[80:83], s55 offen offset:0 lds
  ds_read_b64_tr_b16 a[212:213], v22 offset:12288
  ds_read_b64_tr_b16 a[214:215], v22 offset:13312
  ds_read_b128 a[220:223], v29 offset:0
  v_mfma_f32_32x32x16_bf16 v[200:215], a[232:235], a[244:247], v[200:215]
  buffer_load_dwordx4 v15, s[80:83], s55 offen offset:1024 lds
  ds_read_b128 a[224:227], v29 offset:1024
  ds_read_b128 a[228:231], v33 offset:0
  ds_read_b64_tr_b16 a[216:217], v23 offset:12288
  v_mfma_f32_16x16x32_bf16 v[36:39], a[232:235], a[248:251], v[36:39]
  ds_read_b64_tr_b16 a[218:219], v23 offset:13312
  v_mfma_f32_32x32x16_bf16 v[184:199], a[236:239], a[240:243], v[184:199]
  buffer_load_dwordx4 v16, s[80:83], s55 offen offset:2048 lds
  v_exp_f32 v133, v133
  v_fma_f32 v135, v135, s31, -v238
  v_mfma_f32_32x32x16_bf16 v[216:231], a[236:239], a[244:247], v[216:231]
  v_exp_f32 v134, v134
  v_exp_f32 v135, v135
  v_add_f32 v241, v241, v132
  v_add_f32 v241, v241, v133
  v_mfma_f32_16x16x32_bf16 v[40:43], a[236:239], a[248:251], v[40:43]
  ds_read_b64_tr_b16 a[232:233], v22 offset:14336
  s_waitcnt lgkmcnt(8)
  v_mfma_f32_32x32x16_bf16 v[168:183], a[192:195], a[200:203], v[168:183]
  buffer_load_dwordx4 v17, s[80:83], s55 offen offset:3072 lds
  ds_read_b64_tr_b16 a[234:235], v22 offset:15360
  ds_read_b128 a[240:243], v29 offset:2048
  ds_read_b128 a[244:247], v29 offset:3072
  v_mfma_f32_32x32x16_bf16 v[200:215], a[192:195], a[204:207], v[200:215]
  ds_read_b128 a[248:251], v33 offset:512
  ds_read_b64_tr_b16 a[236:237], v23 offset:14336
  ds_read_b64_tr_b16 a[238:239], v23 offset:15360
  s_waitcnt vmcnt(16)
  ds_read_b128 v[136:139], v18 offset:16384
  s_waitcnt lgkmcnt(13)
  ds_read_b128 v[140:143], v19 offset:16384
  v_mfma_f32_16x16x32_bf16 v[36:39], a[192:195], a[208:211], v[36:39]
  v_cvt_pk_bf16_f32 v8, v132, v133
  v_add_f32 v241, v241, v134
  v_mfma_f32_32x32x16_bf16 v[184:199], a[196:199], a[200:203], v[184:199]
  v_add_f32 v241, v241, v135
  v_cvt_pk_bf16_f32 v9, v134, v135
  ds_write_b128 v24, v[44:47] offset:20480
  s_waitcnt lgkmcnt(13)
  ds_write_b128 v24, v[48:51] offset:21504
  ds_write_b128 v24, v[52:55] offset:22528
  v_mfma_f32_32x32x16_bf16 v[216:231], a[196:199], a[204:207], v[216:231]
  s_waitcnt lgkmcnt(13)
  ds_read_b128 v[144:147], v20 offset:16384
  ds_write_b128 v24, v[4:7] offset:23552
  s_waitcnt lgkmcnt(13)
  ds_write_b64 v25, v[8:9] offset:20480
  v_mfma_f32_16x16x32_bf16 v[40:43], a[196:199], a[208:211], v[40:43]
  s_add_u32 m0, s30, 8192
  v_mfma_f32_32x32x16_bf16 v[168:183], a[212:215], a[220:223], v[168:183]
  buffer_load_dwordx4 v14, s[84:87], s55 offen offset:0 lds
  v_mfma_f32_32x32x16_bf16 v[200:215], a[212:215], a[224:227], v[200:215]
  buffer_load_dwordx4 v15, s[84:87], s55 offen offset:1024 lds
  ds_read_b128 v[148:151], v21 offset:16384
  v_mfma_f32_16x16x32_bf16 v[36:39], a[212:215], a[228:231], v[36:39]
  v_mfma_f32_32x32x16_bf16 v[184:199], a[216:219], a[220:223], v[184:199]
  buffer_load_dwordx4 v16, s[84:87], s55 offen offset:2048 lds
  v_mfma_f32_32x32x16_bf16 v[216:231], a[216:219], a[224:227], v[216:231]
  s_waitcnt vmcnt(15) lgkmcnt(13)
  ds_read_b128 v[152:155], v18 offset:20480
  v_mfma_f32_16x16x32_bf16 v[40:43], a[216:219], a[228:231], v[40:43]
  s_waitcnt lgkmcnt(10)
  v_mfma_f32_32x32x16_bf16 v[168:183], a[232:235], a[240:243], v[168:183]
  buffer_load_dwordx4 v17, s[84:87], s55 offen offset:3072 lds
  v_mfma_f32_32x32x16_bf16 v[200:215], a[232:235], a[244:247], v[200:215]
  ds_read_b128 v[156:159], v19 offset:20480
  v_mfma_f32_16x16x32_bf16 v[36:39], a[232:235], a[248:251], v[36:39]
  v_mfma_f32_32x32x16_bf16 v[184:199], a[236:239], a[240:243], v[184:199]
  v_mfma_f32_32x32x16_bf16 v[216:231], a[236:239], a[244:247], v[216:231]
  ds_read_b128 v[160:163], v20 offset:20480
  v_mfma_f32_16x16x32_bf16 v[40:43], a[236:239], a[248:251], v[40:43]
  s_add_u32 m0, s30, 12288
  s_waitcnt lgkmcnt(4)
  s_barrier
  v_mfma_f32_32x32x16_bf16 v[100:115], v[136:139], a[0:3], 0
  buffer_load_dwordx4 v14, s[88:91], s55 offen offset:0 lds
  v_fma_f32 v64, v64, s31, -v236
  v_fma_f32 v65, v65, s31, -v236
  v_mfma_f32_32x32x16_bf16 v[116:131], v[136:139], a[64:67], 0
  buffer_load_dwordx4 v15, s[88:91], s55 offen offset:1024 lds
  ds_read_b128 v[164:167], v21 offset:20480
  v_exp_f32 v64, v64
  v_mfma_f32_16x16x32_bf16 v[132:135], v[136:139], a[128:131], 0
  v_fma_f32 v66, v66, s31, -v236
  v_mfma_f32_32x32x16_bf16 v[100:115], v[140:143], a[4:7], v[100:115]
  buffer_load_dwordx4 v16, s[88:91], s55 offen offset:2048 lds
  v_exp_f32 v65, v65
  v_fma_f32 v67, v67, s31, -v236
  v_mfma_f32_32x32x16_bf16 v[116:131], v[140:143], a[68:71], v[116:131]
  s_waitcnt vmcnt(15)
  ds_read_b128 v[136:139], v18 offset:24576
  v_exp_f32 v66, v66
  v_fma_f32 v68, v68, s31, -v236
  v_mfma_f32_16x16x32_bf16 v[132:135], v[140:143], a[132:135], v[132:135]
  v_mfma_f32_32x32x16_bf16 v[100:115], v[144:147], a[8:11], v[100:115]
  buffer_load_dwordx4 v17, s[88:91], s55 offen offset:3072 lds
  v_exp_f32 v67, v67
  v_fma_f32 v69, v69, s31, -v236
  v_mfma_f32_32x32x16_bf16 v[116:131], v[144:147], a[72:75], v[116:131]
  ds_read_b128 v[140:143], v19 offset:24576
  v_exp_f32 v68, v68
  v_fma_f32 v70, v70, s31, -v236
  v_exp_f32 v69, v69
  v_mfma_f32_16x16x32_bf16 v[132:135], v[144:147], a[136:139], v[132:135]
  v_fma_f32 v71, v71, s31, -v236
  s_waitcnt lgkmcnt(6)
  v_mfma_f32_32x32x16_bf16 v[100:115], v[148:151], a[12:15], v[100:115]
  v_exp_f32 v70, v70
  v_exp_f32 v71, v71
  v_mfma_f32_32x32x16_bf16 v[116:131], v[148:151], a[76:79], v[116:131]
  ds_read_b128 v[144:147], v20 offset:24576
  v_add_f32 v239, v239, v64
  v_add_f32 v239, v239, v65
  v_mfma_f32_16x16x32_bf16 v[132:135], v[148:151], a[140:143], v[132:135]
  s_add_u32 m0, s30, 16384
  s_waitcnt lgkmcnt(6)
  v_mfma_f32_32x32x16_bf16 v[100:115], v[152:155], a[16:19], v[100:115]
  buffer_load_dwordx4 v14, s[92:95], s55 offen offset:0 lds
  v_cvt_pk_bf16_f32 v44, v64, v65
  v_add_f32 v239, v239, v66
  v_add_f32 v239, v239, v67
  v_mfma_f32_32x32x16_bf16 v[116:131], v[152:155], a[80:83], v[116:131]
  buffer_load_dwordx4 v15, s[92:95], s55 offen offset:1024 lds
  ds_read_b128 v[148:151], v21 offset:24576
  v_cvt_pk_bf16_f32 v45, v66, v67
  v_add_f32 v239, v239, v68
  v_mfma_f32_16x16x32_bf16 v[132:135], v[152:155], a[144:147], v[132:135]
  v_add_f32 v239, v239, v69
  s_waitcnt lgkmcnt(6)
  v_mfma_f32_32x32x16_bf16 v[100:115], v[156:159], a[20:23], v[100:115]
  buffer_load_dwordx4 v16, s[92:95], s55 offen offset:2048 lds
  v_cvt_pk_bf16_f32 v46, v68, v69
  v_add_f32 v239, v239, v70
  v_add_f32 v239, v239, v71
  v_mfma_f32_32x32x16_bf16 v[116:131], v[156:159], a[84:87], v[116:131]
  s_waitcnt vmcnt(15)
  ds_read_b128 v[152:155], v18 offset:0
  v_cvt_pk_bf16_f32 v47, v70, v71
  v_fma_f32 v80, v80, s31, -v237
  v_fma_f32 v81, v81, s31, -v237
  v_mfma_f32_16x16x32_bf16 v[132:135], v[156:159], a[148:151], v[132:135]
  s_waitcnt lgkmcnt(6)
  v_mfma_f32_32x32x16_bf16 v[100:115], v[160:163], a[24:27], v[100:115]
  buffer_load_dwordx4 v17, s[92:95], s55 offen offset:3072 lds
  v_exp_f32 v80, v80
  v_fma_f32 v82, v82, s31, -v237
  v_mfma_f32_32x32x16_bf16 v[116:131], v[160:163], a[88:91], v[116:131]
  ds_read_b128 v[156:159], v19 offset:0
  v_exp_f32 v81, v81
  v_fma_f32 v83, v83, s31, -v237
  v_exp_f32 v82, v82
  v_mfma_f32_16x16x32_bf16 v[132:135], v[160:163], a[152:155], v[132:135]
  v_fma_f32 v84, v84, s31, -v237
  s_waitcnt lgkmcnt(6)
  v_mfma_f32_32x32x16_bf16 v[100:115], v[164:167], a[28:31], v[100:115]
  v_exp_f32 v83, v83
  v_mfma_f32_32x32x16_bf16 v[116:131], v[164:167], a[92:95], v[116:131]
  ds_read_b128 v[160:163], v20 offset:0
  v_fma_f32 v85, v85, s31, -v237
  v_exp_f32 v84, v84
  v_mfma_f32_16x16x32_bf16 v[132:135], v[164:167], a[156:159], v[132:135]
  s_add_u32 m0, s30, 20480
  s_waitcnt lgkmcnt(6)
  v_mfma_f32_32x32x16_bf16 v[100:115], v[136:139], a[32:35], v[100:115]
  buffer_load_dwordx4 v10, s[64:67], s58 offen offset:0 lds
  v_fma_f32 v86, v86, s31, -v237
  v_exp_f32 v85, v85
  v_mfma_f32_32x32x16_bf16 v[116:131], v[136:139], a[96:99], v[116:131]
  buffer_load_dwordx4 v11, s[64:67], s58 offen offset:1024 lds
  ds_read_b128 v[164:167], v21 offset:0
  v_fma_f32 v87, v87, s31, -v237
  v_mfma_f32_16x16x32_bf16 v[132:135], v[136:139], a[160:163], v[132:135]
  s_waitcnt lgkmcnt(6)
  v_mfma_f32_32x32x16_bf16 v[100:115], v[140:143], a[36:39], v[100:115]
  buffer_load_dwordx4 v12, s[64:67], s58 offen offset:2048 lds
  v_exp_f32 v86, v86
  v_mfma_f32_32x32x16_bf16 v[116:131], v[140:143], a[100:103], v[116:131]
  s_waitcnt vmcnt(15)
  ds_read_b64_tr_b16 a[192:193], v22 offset:4096
  ds_read_b64_tr_b16 a[194:195], v22 offset:5120
  ds_read_b128 a[200:203], v26 offset:20480
  ds_read_b128 a[204:207], v26 offset:21504
  ds_read_b128 a[208:211], v30 offset:20480
  v_mfma_f32_16x16x32_bf16 v[132:135], v[140:143], a[164:167], v[132:135]
  ds_read_b64_tr_b16 a[196:197], v23 offset:4096
  s_waitcnt lgkmcnt(11)
  v_mfma_f32_32x32x16_bf16 v[100:115], v[144:147], a[40:43], v[100:115]
  buffer_load_dwordx4 v13, s[64:67], s58 offen offset:3072 lds
  ds_read_b64_tr_b16 a[198:199], v23 offset:5120
  v_exp_f32 v87, v87
  v_mfma_f32_32x32x16_bf16 v[116:131], v[144:147], a[104:107], v[116:131]
  v_add_f32 v240, v240, v80
  v_add_f32 v240, v240, v81
  v_cvt_pk_bf16_f32 v48, v80, v81
  v_add_f32 v240, v240, v82
  v_add_f32 v240, v240, v83
  v_cvt_pk_bf16_f32 v49, v82, v83
  v_mfma_f32_16x16x32_bf16 v[132:135], v[144:147], a[168:171], v[132:135]
  v_add_f32 v240, v240, v84
  s_waitcnt lgkmcnt(11)
  v_mfma_f32_32x32x16_bf16 v[100:115], v[148:151], a[44:47], v[100:115]
  v_add_f32 v240, v240, v85
  v_cvt_pk_bf16_f32 v50, v84, v85
  v_add_f32 v240, v240, v86
  v_add_f32 v240, v240, v87
  v_cvt_pk_bf16_f32 v51, v86, v87
  v_fma_f32 v72, v72, s31, -v236
  v_mfma_f32_32x32x16_bf16 v[116:131], v[148:151], a[108:111], v[116:131]
  ds_read_b64_tr_b16 a[212:213], v22 offset:6144
  ds_read_b64_tr_b16 a[214:215], v22 offset:7168
  ds_read_b128 a[220:223], v26 offset:22528
  ds_read_b128 a[224:227], v26 offset:23552
  s_waitcnt lgkmcnt(13)
  ds_read_b128 a[228:231], v30 offset:20992
  v_mfma_f32_16x16x32_bf16 v[132:135], v[148:151], a[172:175], v[132:135]
  s_add_u32 m0, s30, 24576
  v_mfma_f32_32x32x16_bf16 v[100:115], v[152:155], a[48:51], v[100:115]
  buffer_load_dwordx4 v10, s[68:71], s58 offen offset:0 lds
  ds_read_b64_tr_b16 a[216:217], v23 offset:6144
  s_waitcnt lgkmcnt(13)
  ds_read_b64_tr_b16 a[218:219], v23 offset:7168
  v_mfma_f32_32x32x16_bf16 v[116:131], v[152:155], a[112:115], v[116:131]
  buffer_load_dwordx4 v11, s[68:71], s58 offen offset:1024 lds
  v_fma_f32 v73, v73, s31, -v236
  v_exp_f32 v72, v72
  v_mfma_f32_16x16x32_bf16 v[132:135], v[152:155], a[176:179], v[132:135]
  v_fma_f32 v74, v74, s31, -v236
  v_mfma_f32_32x32x16_bf16 v[100:115], v[156:159], a[52:55], v[100:115]
  buffer_load_dwordx4 v12, s[68:71], s58 offen offset:2048 lds
  v_exp_f32 v73, v73
  v_fma_f32 v75, v75, s31, -v236
  v_mfma_f32_32x32x16_bf16 v[116:131], v[156:159], a[116:119], v[116:131]
  s_waitcnt vmcnt(15)
  ds_read_b64_tr_b16 a[232:233], v22 offset:8192
  s_waitcnt lgkmcnt(13)
  ds_read_b64_tr_b16 a[234:235], v22 offset:9216
  ds_read_b128 a[240:243], v27 offset:20480
  s_waitcnt lgkmcnt(13)
  ds_read_b128 a[244:247], v27 offset:21504
  v_mfma_f32_16x16x32_bf16 v[132:135], v[156:159], a[180:183], v[132:135]
  ds_read_b128 a[248:251], v31 offset:20480
  v_mfma_f32_32x32x16_bf16 v[100:115], v[160:163], a[56:59], v[100:115]
  buffer_load_dwordx4 v13, s[68:71], s58 offen offset:3072 lds
  s_waitcnt lgkmcnt(13)
  ds_read_b64_tr_b16 a[236:237], v23 offset:8192
  ds_read_b64_tr_b16 a[238:239], v23 offset:9216
  v_mfma_f32_32x32x16_bf16 v[116:131], v[160:163], a[120:123], v[116:131]
  v_exp_f32 v74, v74
  v_fma_f32 v76, v76, s31, -v236
  v_exp_f32 v75, v75
  v_fma_f32 v77, v77, s31, -v236
  v_mfma_f32_16x16x32_bf16 v[132:135], v[160:163], a[184:187], v[132:135]
  v_mfma_f32_32x32x16_bf16 v[100:115], v[164:167], a[60:63], v[100:115]
  v_exp_f32 v76, v76
  v_fma_f32 v78, v78, s31, -v236
  v_exp_f32 v77, v77
  v_fma_f32 v79, v79, s31, -v236
  v_mfma_f32_32x32x16_bf16 v[116:131], v[164:167], a[124:127], v[116:131]
  v_exp_f32 v78, v78
  v_exp_f32 v79, v79
  v_add_f32 v239, v239, v72
  v_add_f32 v239, v239, v73
  v_mfma_f32_16x16x32_bf16 v[132:135], v[164:167], a[188:191], v[132:135]
  s_add_u32 m0, s30, 0
  s_waitcnt lgkmcnt(14)
  v_mfma_f32_32x32x16_bf16 v[168:183], a[192:195], a[200:203], v[168:183]
  buffer_load_dwordx4 v10, s[72:75], s58 offen offset:0 lds
  v_cvt_pk_bf16_f32 v52, v72, v73
  v_add_f32 v239, v239, v74
  v_add_f32 v239, v239, v75
  v_mfma_f32_32x32x16_bf16 v[200:215], a[192:195], a[204:207], v[200:215]
  buffer_load_dwordx4 v11, s[72:75], s58 offen offset:1024 lds
  v_cvt_pk_bf16_f32 v53, v74, v75
  v_add_f32 v239, v239, v76
  v_add_f32 v239, v239, v77
  v_mfma_f32_16x16x32_bf16 v[36:39], a[192:195], a[208:211], v[36:39]
  v_cvt_pk_bf16_f32 v54, v76, v77
  v_add_f32 v239, v239, v78
  v_mfma_f32_32x32x16_bf16 v[184:199], a[196:199], a[200:203], v[184:199]
  buffer_load_dwordx4 v12, s[72:75], s58 offen offset:2048 lds
  v_add_f32 v239, v239, v79
  v_cvt_pk_bf16_f32 v55, v78, v79
  v_fma_f32 v88, v88, s31, -v237
  v_mfma_f32_32x32x16_bf16 v[216:231], a[196:199], a[204:207], v[216:231]
  v_fma_f32 v89, v89, s31, -v237
  v_exp_f32 v88, v88
  v_mfma_f32_16x16x32_bf16 v[40:43], a[196:199], a[208:211], v[40:43]
  ds_read_b64_tr_b16 a[192:193], v22 offset:10240
  s_waitcnt lgkmcnt(8)
  v_mfma_f32_32x32x16_bf16 v[168:183], a[212:215], a[220:223], v[168:183]
  buffer_load_dwordx4 v13, s[72:75], s58 offen offset:3072 lds
  ds_read_b64_tr_b16 a[194:195], v22 offset:11264
  ds_read_b128 a[200:203], v27 offset:22528
  ds_read_b128 a[204:207], v27 offset:23552
  v_mfma_f32_32x32x16_bf16 v[200:215], a[212:215], a[224:227], v[200:215]
  ds_read_b128 a[208:211], v31 offset:20992
  ds_read_b64_tr_b16 a[196:197], v23 offset:10240
  ds_read_b64_tr_b16 a[198:199], v23 offset:11264
  v_fma_f32 v90, v90, s31, -v237
  v_exp_f32 v89, v89
  v_mfma_f32_16x16x32_bf16 v[36:39], a[212:215], a[228:231], v[36:39]
  v_fma_f32 v91, v91, s31, -v237
  v_mfma_f32_32x32x16_bf16 v[184:199], a[216:219], a[220:223], v[184:199]
  v_exp_f32 v90, v90
  v_fma_f32 v92, v92, s31, -v237
  v_exp_f32 v91, v91
  v_fma_f32 v93, v93, s31, -v237
  v_mfma_f32_32x32x16_bf16 v[216:231], a[216:219], a[224:227], v[216:231]
  v_exp_f32 v92, v92
  v_fma_f32 v94, v94, s31, -v237
  v_mfma_f32_16x16x32_bf16 v[40:43], a[216:219], a[228:231], v[40:43]
  s_add_u32 m0, s30, 4096
  s_waitcnt vmcnt(16) lgkmcnt(7)
  v_mfma_f32_32x32x16_bf16 v[168:183], a[232:235], a[240:243], v[168:183]
  buffer_load_dwordx4 v10, s[76:79], s58 offen offset:0 lds
  ds_read_b64_tr_b16 a[212:213], v22 offset:12288
  ds_read_b64_tr_b16 a[214:215], v22 offset:13312
  ds_read_b128 a[220:223], v28 offset:20480
  v_mfma_f32_32x32x16_bf16 v[200:215], a[232:235], a[244:247], v[200:215]
  buffer_load_dwordx4 v11, s[76:79], s58 offen offset:1024 lds
  ds_read_b128 a[224:227], v28 offset:21504
  ds_read_b128 a[228:231], v32 offset:20480
  ds_read_b64_tr_b16 a[216:217], v23 offset:12288
  v_mfma_f32_16x16x32_bf16 v[36:39], a[232:235], a[248:251], v[36:39]
  ds_read_b64_tr_b16 a[218:219], v23 offset:13312
  v_mfma_f32_32x32x16_bf16 v[184:199], a[236:239], a[240:243], v[184:199]
  buffer_load_dwordx4 v12, s[76:79], s58 offen offset:2048 lds
  v_exp_f32 v93, v93
  v_fma_f32 v95, v95, s31, -v237
  v_mfma_f32_32x32x16_bf16 v[216:231], a[236:239], a[244:247], v[216:231]
  v_exp_f32 v94, v94
  v_exp_f32 v95, v95
  v_add_f32 v240, v240, v88
  v_add_f32 v240, v240, v89
  v_mfma_f32_16x16x32_bf16 v[40:43], a[236:239], a[248:251], v[40:43]
  ds_read_b64_tr_b16 a[232:233], v22 offset:14336
  s_waitcnt lgkmcnt(8)
  v_mfma_f32_32x32x16_bf16 v[168:183], a[192:195], a[200:203], v[168:183]
  buffer_load_dwordx4 v13, s[76:79], s58 offen offset:3072 lds
  ds_read_b64_tr_b16 a[234:235], v22 offset:15360
  ds_read_b128 a[240:243], v28 offset:22528
  ds_read_b128 a[244:247], v28 offset:23552
  v_mfma_f32_32x32x16_bf16 v[200:215], a[192:195], a[204:207], v[200:215]
  ds_read_b128 a[248:251], v32 offset:20992
  ds_read_b64_tr_b16 a[236:237], v23 offset:14336
  ds_read_b64_tr_b16 a[238:239], v23 offset:15360
  v_cvt_pk_bf16_f32 v4, v88, v89
  v_add_f32 v240, v240, v90
  v_add_f32 v240, v240, v91
  v_mfma_f32_16x16x32_bf16 v[36:39], a[192:195], a[208:211], v[36:39]
  v_cvt_pk_bf16_f32 v5, v90, v91
  v_add_f32 v240, v240, v92
  v_mfma_f32_32x32x16_bf16 v[184:199], a[196:199], a[200:203], v[184:199]
  v_add_f32 v240, v240, v93
  v_cvt_pk_bf16_f32 v6, v92, v93
  v_add_f32 v240, v240, v94
  v_add_f32 v240, v240, v95
  v_cvt_pk_bf16_f32 v7, v94, v95
  v_fma_f32 v96, v96, s31, -v238
  v_mfma_f32_32x32x16_bf16 v[216:231], a[196:199], a[204:207], v[216:231]
  v_fma_f32 v97, v97, s31, -v238
  v_exp_f32 v96, v96
  v_fma_f32 v98, v98, s31, -v238
  v_mfma_f32_16x16x32_bf16 v[40:43], a[196:199], a[208:211], v[40:43]
  s_add_u32 m0, s30, 8192
  s_waitcnt vmcnt(16) lgkmcnt(7)
  v_mfma_f32_32x32x16_bf16 v[168:183], a[212:215], a[220:223], v[168:183]
  buffer_load_dwordx4 v14, s[80:83], s56 offen offset:0 lds
  ds_read_b64_tr_b16 a[192:193], v22 offset:16384
  ds_read_b64_tr_b16 a[194:195], v22 offset:17408
  ds_read_b128 a[200:203], v29 offset:20480
  v_mfma_f32_32x32x16_bf16 v[200:215], a[212:215], a[224:227], v[200:215]
  buffer_load_dwordx4 v15, s[80:83], s56 offen offset:1024 lds
  ds_read_b128 a[204:207], v29 offset:21504
  ds_read_b128 a[208:211], v33 offset:20480
  ds_read_b64_tr_b16 a[196:197], v23 offset:16384
  v_mfma_f32_16x16x32_bf16 v[36:39], a[212:215], a[228:231], v[36:39]
  ds_read_b64_tr_b16 a[198:199], v23 offset:17408
  v_mfma_f32_32x32x16_bf16 v[184:199], a[216:219], a[220:223], v[184:199]
  buffer_load_dwordx4 v16, s[80:83], s56 offen offset:2048 lds
  v_exp_f32 v97, v97
  v_fma_f32 v99, v99, s31, -v238
  v_mfma_f32_32x32x16_bf16 v[216:231], a[216:219], a[224:227], v[216:231]
  v_exp_f32 v98, v98
  v_exp_f32 v99, v99
  v_add_f32 v241, v241, v96
  v_add_f32 v241, v241, v97
  v_mfma_f32_16x16x32_bf16 v[40:43], a[216:219], a[228:231], v[40:43]
  ds_read_b64_tr_b16 a[212:213], v22 offset:18432
  s_waitcnt lgkmcnt(8)
  v_mfma_f32_32x32x16_bf16 v[168:183], a[232:235], a[240:243], v[168:183]
  buffer_load_dwordx4 v17, s[80:83], s56 offen offset:3072 lds
  ds_read_b64_tr_b16 a[214:215], v22 offset:19456
  ds_read_b128 a[220:223], v29 offset:22528
  ds_read_b128 a[224:227], v29 offset:23552
  v_mfma_f32_32x32x16_bf16 v[200:215], a[232:235], a[244:247], v[200:215]
  ds_read_b128 a[228:231], v33 offset:20992
  ds_read_b64_tr_b16 a[216:217], v23 offset:18432
  ds_read_b64_tr_b16 a[218:219], v23 offset:19456
  s_waitcnt vmcnt(16)
  ds_read_b128 v[136:139], v18 offset:20480
  s_waitcnt lgkmcnt(13)
  ds_read_b128 v[140:143], v19 offset:20480
  v_mfma_f32_16x16x32_bf16 v[36:39], a[232:235], a[248:251], v[36:39]
  v_cvt_pk_bf16_f32 v8, v96, v97
  v_add_f32 v241, v241, v98
  v_mfma_f32_32x32x16_bf16 v[184:199], a[236:239], a[240:243], v[184:199]
  v_add_f32 v241, v241, v99
  v_cvt_pk_bf16_f32 v9, v98, v99
  ds_write_b128 v24, v[44:47] offset:0
  s_waitcnt lgkmcnt(13)
  ds_write_b128 v24, v[48:51] offset:1024
  ds_write_b128 v24, v[52:55] offset:2048
  v_mfma_f32_32x32x16_bf16 v[216:231], a[236:239], a[244:247], v[216:231]
  s_waitcnt lgkmcnt(13)
  ds_read_b128 v[144:147], v20 offset:20480
  ds_write_b128 v24, v[4:7] offset:3072
  s_waitcnt lgkmcnt(13)
  ds_write_b64 v25, v[8:9] offset:0
  v_mfma_f32_16x16x32_bf16 v[40:43], a[236:239], a[248:251], v[40:43]
  s_add_u32 m0, s30, 12288
  v_mfma_f32_32x32x16_bf16 v[168:183], a[192:195], a[200:203], v[168:183]
  buffer_load_dwordx4 v14, s[84:87], s56 offen offset:0 lds
  v_mfma_f32_32x32x16_bf16 v[200:215], a[192:195], a[204:207], v[200:215]
  buffer_load_dwordx4 v15, s[84:87], s56 offen offset:1024 lds
  ds_read_b128 v[148:151], v21 offset:20480
  v_mfma_f32_16x16x32_bf16 v[36:39], a[192:195], a[208:211], v[36:39]
  v_mfma_f32_32x32x16_bf16 v[184:199], a[196:199], a[200:203], v[184:199]
  buffer_load_dwordx4 v16, s[84:87], s56 offen offset:2048 lds
  v_mfma_f32_32x32x16_bf16 v[216:231], a[196:199], a[204:207], v[216:231]
  s_waitcnt vmcnt(15) lgkmcnt(13)
  ds_read_b128 v[152:155], v18 offset:24576
  v_mfma_f32_16x16x32_bf16 v[40:43], a[196:199], a[208:211], v[40:43]
  s_waitcnt lgkmcnt(10)
  v_mfma_f32_32x32x16_bf16 v[168:183], a[212:215], a[220:223], v[168:183]
  buffer_load_dwordx4 v17, s[84:87], s56 offen offset:3072 lds
  v_mfma_f32_32x32x16_bf16 v[200:215], a[212:215], a[224:227], v[200:215]
  ds_read_b128 v[156:159], v19 offset:24576
  v_mfma_f32_16x16x32_bf16 v[36:39], a[212:215], a[228:231], v[36:39]
  v_mfma_f32_32x32x16_bf16 v[184:199], a[216:219], a[220:223], v[184:199]
  v_mfma_f32_32x32x16_bf16 v[216:231], a[216:219], a[224:227], v[216:231]
  ds_read_b128 v[160:163], v20 offset:24576
  v_mfma_f32_16x16x32_bf16 v[40:43], a[216:219], a[228:231], v[40:43]
  s_add_u32 m0, s30, 16384
  s_waitcnt lgkmcnt(4)
  s_barrier
  v_mfma_f32_32x32x16_bf16 v[64:79], v[136:139], a[0:3], 0
  buffer_load_dwordx4 v14, s[88:91], s56 offen offset:0 lds
  v_fma_f32 v100, v100, s31, -v236
  v_fma_f32 v101, v101, s31, -v236
  v_mfma_f32_32x32x16_bf16 v[80:95], v[136:139], a[64:67], 0
  buffer_load_dwordx4 v15, s[88:91], s56 offen offset:1024 lds
  ds_read_b128 v[164:167], v21 offset:24576
  v_exp_f32 v100, v100
  v_mfma_f32_16x16x32_bf16 v[96:99], v[136:139], a[128:131], 0
  v_fma_f32 v102, v102, s31, -v236
  v_mfma_f32_32x32x16_bf16 v[64:79], v[140:143], a[4:7], v[64:79]
  buffer_load_dwordx4 v16, s[88:91], s56 offen offset:2048 lds
  v_exp_f32 v101, v101
  v_fma_f32 v103, v103, s31, -v236
  v_mfma_f32_32x32x16_bf16 v[80:95], v[140:143], a[68:71], v[80:95]
  s_waitcnt vmcnt(15)
  ds_read_b128 v[136:139], v18 offset:0
  v_exp_f32 v102, v102
  v_fma_f32 v104, v104, s31, -v236
  v_mfma_f32_16x16x32_bf16 v[96:99], v[140:143], a[132:135], v[96:99]
  v_mfma_f32_32x32x16_bf16 v[64:79], v[144:147], a[8:11], v[64:79]
  buffer_load_dwordx4 v17, s[88:91], s56 offen offset:3072 lds
  v_exp_f32 v103, v103
  v_fma_f32 v105, v105, s31, -v236
  v_mfma_f32_32x32x16_bf16 v[80:95], v[144:147], a[72:75], v[80:95]
  ds_read_b128 v[140:143], v19 offset:0
  v_exp_f32 v104, v104
  v_fma_f32 v106, v106, s31, -v236
  v_exp_f32 v105, v105
  v_mfma_f32_16x16x32_bf16 v[96:99], v[144:147], a[136:139], v[96:99]
  v_fma_f32 v107, v107, s31, -v236
  s_waitcnt lgkmcnt(6)
  v_mfma_f32_32x32x16_bf16 v[64:79], v[148:151], a[12:15], v[64:79]
  v_exp_f32 v106, v106
  v_exp_f32 v107, v107
  v_mfma_f32_32x32x16_bf16 v[80:95], v[148:151], a[76:79], v[80:95]
  ds_read_b128 v[144:147], v20 offset:0
  v_add_f32 v239, v239, v100
  v_add_f32 v239, v239, v101
  v_mfma_f32_16x16x32_bf16 v[96:99], v[148:151], a[140:143], v[96:99]
  s_add_u32 m0, s30, 20480
  s_waitcnt lgkmcnt(6)
  v_mfma_f32_32x32x16_bf16 v[64:79], v[152:155], a[16:19], v[64:79]
  buffer_load_dwordx4 v14, s[92:95], s56 offen offset:0 lds
  v_cvt_pk_bf16_f32 v44, v100, v101
  v_add_f32 v239, v239, v102
  v_add_f32 v239, v239, v103
  v_mfma_f32_32x32x16_bf16 v[80:95], v[152:155], a[80:83], v[80:95]
  buffer_load_dwordx4 v15, s[92:95], s56 offen offset:1024 lds
  ds_read_b128 v[148:151], v21 offset:0
  v_cvt_pk_bf16_f32 v45, v102, v103
  v_add_f32 v239, v239, v104
  v_mfma_f32_16x16x32_bf16 v[96:99], v[152:155], a[144:147], v[96:99]
  v_add_f32 v239, v239, v105
  s_waitcnt lgkmcnt(6)
  v_mfma_f32_32x32x16_bf16 v[64:79], v[156:159], a[20:23], v[64:79]
  buffer_load_dwordx4 v16, s[92:95], s56 offen offset:2048 lds
  v_cvt_pk_bf16_f32 v46, v104, v105
  v_add_f32 v239, v239, v106
  v_add_f32 v239, v239, v107
  v_mfma_f32_32x32x16_bf16 v[80:95], v[156:159], a[84:87], v[80:95]
  s_waitcnt vmcnt(15)
  ds_read_b128 v[152:155], v18 offset:4096
  v_cvt_pk_bf16_f32 v47, v106, v107
  v_fma_f32 v116, v116, s31, -v237
  v_fma_f32 v117, v117, s31, -v237
  v_mfma_f32_16x16x32_bf16 v[96:99], v[156:159], a[148:151], v[96:99]
  s_waitcnt lgkmcnt(6)
  v_mfma_f32_32x32x16_bf16 v[64:79], v[160:163], a[24:27], v[64:79]
  buffer_load_dwordx4 v17, s[92:95], s56 offen offset:3072 lds
  v_exp_f32 v116, v116
  v_fma_f32 v118, v118, s31, -v237
  v_mfma_f32_32x32x16_bf16 v[80:95], v[160:163], a[88:91], v[80:95]
  ds_read_b128 v[156:159], v19 offset:4096
  v_exp_f32 v117, v117
  v_fma_f32 v119, v119, s31, -v237
  v_exp_f32 v118, v118
  v_mfma_f32_16x16x32_bf16 v[96:99], v[160:163], a[152:155], v[96:99]
  v_fma_f32 v120, v120, s31, -v237
  s_waitcnt lgkmcnt(6)
  v_mfma_f32_32x32x16_bf16 v[64:79], v[164:167], a[28:31], v[64:79]
  v_exp_f32 v119, v119
  v_mfma_f32_32x32x16_bf16 v[80:95], v[164:167], a[92:95], v[80:95]
  ds_read_b128 v[160:163], v20 offset:4096
  v_fma_f32 v121, v121, s31, -v237
  v_exp_f32 v120, v120
  v_mfma_f32_16x16x32_bf16 v[96:99], v[164:167], a[156:159], v[96:99]
  s_add_u32 m0, s30, 24576
  s_waitcnt lgkmcnt(6)
  v_mfma_f32_32x32x16_bf16 v[64:79], v[136:139], a[32:35], v[64:79]
  buffer_load_dwordx4 v10, s[64:67], s59 offen offset:0 lds
  v_fma_f32 v122, v122, s31, -v237
  v_exp_f32 v121, v121
  v_mfma_f32_32x32x16_bf16 v[80:95], v[136:139], a[96:99], v[80:95]
  buffer_load_dwordx4 v11, s[64:67], s59 offen offset:1024 lds
  ds_read_b128 v[164:167], v21 offset:4096
  v_fma_f32 v123, v123, s31, -v237
  v_mfma_f32_16x16x32_bf16 v[96:99], v[136:139], a[160:163], v[96:99]
  s_waitcnt lgkmcnt(6)
  v_mfma_f32_32x32x16_bf16 v[64:79], v[140:143], a[36:39], v[64:79]
  buffer_load_dwordx4 v12, s[64:67], s59 offen offset:2048 lds
  v_exp_f32 v122, v122
  v_mfma_f32_32x32x16_bf16 v[80:95], v[140:143], a[100:103], v[80:95]
  s_waitcnt vmcnt(15)
  ds_read_b64_tr_b16 a[232:233], v22 offset:8192
  ds_read_b64_tr_b16 a[234:235], v22 offset:9216
  ds_read_b128 a[240:243], v26 offset:0
  ds_read_b128 a[244:247], v26 offset:1024
  ds_read_b128 a[248:251], v30 offset:0
  v_mfma_f32_16x16x32_bf16 v[96:99], v[140:143], a[164:167], v[96:99]
  ds_read_b64_tr_b16 a[236:237], v23 offset:8192
  s_waitcnt lgkmcnt(11)
  v_mfma_f32_32x32x16_bf16 v[64:79], v[144:147], a[40:43], v[64:79]
  buffer_load_dwordx4 v13, s[64:67], s59 offen offset:3072 lds
  ds_read_b64_tr_b16 a[238:239], v23 offset:9216
  v_exp_f32 v123, v123
  v_mfma_f32_32x32x16_bf16 v[80:95], v[144:147], a[104:107], v[80:95]
  v_add_f32 v240, v240, v116
  v_add_f32 v240, v240, v117
  v_cvt_pk_bf16_f32 v48, v116, v117
  v_add_f32 v240, v240, v118
  v_add_f32 v240, v240, v119
  v_cvt_pk_bf16_f32 v49, v118, v119
  v_mfma_f32_16x16x32_bf16 v[96:99], v[144:147], a[168:171], v[96:99]
  v_add_f32 v240, v240, v120
  s_waitcnt lgkmcnt(11)
  v_mfma_f32_32x32x16_bf16 v[64:79], v[148:151], a[44:47], v[64:79]
  v_add_f32 v240, v240, v121
  v_cvt_pk_bf16_f32 v50, v120, v121
  v_add_f32 v240, v240, v122
  v_add_f32 v240, v240, v123
  v_cvt_pk_bf16_f32 v51, v122, v123
  v_fma_f32 v108, v108, s31, -v236
  v_mfma_f32_32x32x16_bf16 v[80:95], v[148:151], a[108:111], v[80:95]
  ds_read_b64_tr_b16 a[192:193], v22 offset:10240
  ds_read_b64_tr_b16 a[194:195], v22 offset:11264
  ds_read_b128 a[200:203], v26 offset:2048
  ds_read_b128 a[204:207], v26 offset:3072
  s_waitcnt lgkmcnt(13)
  ds_read_b128 a[208:211], v30 offset:512
  v_mfma_f32_16x16x32_bf16 v[96:99], v[148:151], a[172:175], v[96:99]
  s_add_u32 m0, s30, 0
  v_mfma_f32_32x32x16_bf16 v[64:79], v[152:155], a[48:51], v[64:79]
  buffer_load_dwordx4 v10, s[68:71], s59 offen offset:0 lds
  ds_read_b64_tr_b16 a[196:197], v23 offset:10240
  s_waitcnt lgkmcnt(13)
  ds_read_b64_tr_b16 a[198:199], v23 offset:11264
  v_mfma_f32_32x32x16_bf16 v[80:95], v[152:155], a[112:115], v[80:95]
  buffer_load_dwordx4 v11, s[68:71], s59 offen offset:1024 lds
  v_fma_f32 v109, v109, s31, -v236
  v_exp_f32 v108, v108
  v_mfma_f32_16x16x32_bf16 v[96:99], v[152:155], a[176:179], v[96:99]
  v_fma_f32 v110, v110, s31, -v236
  v_mfma_f32_32x32x16_bf16 v[64:79], v[156:159], a[52:55], v[64:79]
  buffer_load_dwordx4 v12, s[68:71], s59 offen offset:2048 lds
  v_exp_f32 v109, v109
  v_fma_f32 v111, v111, s31, -v236
  v_mfma_f32_32x32x16_bf16 v[80:95], v[156:159], a[116:119], v[80:95]
  s_waitcnt vmcnt(15)
  ds_read_b64_tr_b16 a[212:213], v22 offset:12288
  s_waitcnt lgkmcnt(13)
  ds_read_b64_tr_b16 a[214:215], v22 offset:13312
  ds_read_b128 a[220:223], v27 offset:0
  s_waitcnt lgkmcnt(13)
  ds_read_b128 a[224:227], v27 offset:1024
  v_mfma_f32_16x16x32_bf16 v[96:99], v[156:159], a[180:183], v[96:99]
  ds_read_b128 a[228:231], v31 offset:0
  v_mfma_f32_32x32x16_bf16 v[64:79], v[160:163], a[56:59], v[64:79]
  buffer_load_dwordx4 v13, s[68:71], s59 offen offset:3072 lds
  s_waitcnt lgkmcnt(13)
  ds_read_b64_tr_b16 a[216:217], v23 offset:12288
  ds_read_b64_tr_b16 a[218:219], v23 offset:13312
  v_mfma_f32_32x32x16_bf16 v[80:95], v[160:163], a[120:123], v[80:95]
  v_exp_f32 v110, v110
  v_fma_f32 v112, v112, s31, -v236
  v_exp_f32 v111, v111
  v_fma_f32 v113, v113, s31, -v236
  v_mfma_f32_16x16x32_bf16 v[96:99], v[160:163], a[184:187], v[96:99]
  v_mfma_f32_32x32x16_bf16 v[64:79], v[164:167], a[60:63], v[64:79]
  v_exp_f32 v112, v112
  v_fma_f32 v114, v114, s31, -v236
  v_exp_f32 v113, v113
  v_fma_f32 v115, v115, s31, -v236
  v_mfma_f32_32x32x16_bf16 v[80:95], v[164:167], a[124:127], v[80:95]
  v_exp_f32 v114, v114
  v_exp_f32 v115, v115
  v_add_f32 v239, v239, v108
  v_add_f32 v239, v239, v109
  v_mfma_f32_16x16x32_bf16 v[96:99], v[164:167], a[188:191], v[96:99]
  s_add_u32 m0, s30, 4096
  s_waitcnt lgkmcnt(14)
  v_mfma_f32_32x32x16_bf16 v[168:183], a[232:235], a[240:243], v[168:183]
  buffer_load_dwordx4 v10, s[72:75], s59 offen offset:0 lds
  v_cvt_pk_bf16_f32 v52, v108, v109
  v_add_f32 v239, v239, v110
  v_add_f32 v239, v239, v111
  v_mfma_f32_32x32x16_bf16 v[200:215], a[232:235], a[244:247], v[200:215]
  buffer_load_dwordx4 v11, s[72:75], s59 offen offset:1024 lds
  v_cvt_pk_bf16_f32 v53, v110, v111
  v_add_f32 v239, v239, v112
  v_add_f32 v239, v239, v113
  v_mfma_f32_16x16x32_bf16 v[36:39], a[232:235], a[248:251], v[36:39]
  v_cvt_pk_bf16_f32 v54, v112, v113
  v_add_f32 v239, v239, v114
  v_mfma_f32_32x32x16_bf16 v[184:199], a[236:239], a[240:243], v[184:199]
  buffer_load_dwordx4 v12, s[72:75], s59 offen offset:2048 lds
  v_add_f32 v239, v239, v115
  v_cvt_pk_bf16_f32 v55, v114, v115
  v_fma_f32 v124, v124, s31, -v237
  v_mfma_f32_32x32x16_bf16 v[216:231], a[236:239], a[244:247], v[216:231]
  v_fma_f32 v125, v125, s31, -v237
  v_exp_f32 v124, v124
  v_mfma_f32_16x16x32_bf16 v[40:43], a[236:239], a[248:251], v[40:43]
  ds_read_b64_tr_b16 a[232:233], v22 offset:14336
  s_waitcnt lgkmcnt(8)
  v_mfma_f32_32x32x16_bf16 v[168:183], a[192:195], a[200:203], v[168:183]
  buffer_load_dwordx4 v13, s[72:75], s59 offen offset:3072 lds
  ds_read_b64_tr_b16 a[234:235], v22 offset:15360
  ds_read_b128 a[240:243], v27 offset:2048
  ds_read_b128 a[244:247], v27 offset:3072
  v_mfma_f32_32x32x16_bf16 v[200:215], a[192:195], a[204:207], v[200:215]
  ds_read_b128 a[248:251], v31 offset:512
  ds_read_b64_tr_b16 a[236:237], v23 offset:14336
  ds_read_b64_tr_b16 a[238:239], v23 offset:15360
  v_fma_f32 v126, v126, s31, -v237
  v_exp_f32 v125, v125
  v_mfma_f32_16x16x32_bf16 v[36:39], a[192:195], a[208:211], v[36:39]
  v_fma_f32 v127, v127, s31, -v237
  v_mfma_f32_32x32x16_bf16 v[184:199], a[196:199], a[200:203], v[184:199]
  v_exp_f32 v126, v126
  v_fma_f32 v128, v128, s31, -v237
  v_exp_f32 v127, v127
  v_fma_f32 v129, v129, s31, -v237
  v_mfma_f32_32x32x16_bf16 v[216:231], a[196:199], a[204:207], v[216:231]
  v_exp_f32 v128, v128
  v_fma_f32 v130, v130, s31, -v237
  v_mfma_f32_16x16x32_bf16 v[40:43], a[196:199], a[208:211], v[40:43]
  s_add_u32 m0, s30, 8192
  s_waitcnt vmcnt(16) lgkmcnt(7)
  v_mfma_f32_32x32x16_bf16 v[168:183], a[212:215], a[220:223], v[168:183]
  buffer_load_dwordx4 v10, s[76:79], s59 offen offset:0 lds
  ds_read_b64_tr_b16 a[192:193], v22 offset:16384
  ds_read_b64_tr_b16 a[194:195], v22 offset:17408
  ds_read_b128 a[200:203], v28 offset:0
  v_mfma_f32_32x32x16_bf16 v[200:215], a[212:215], a[224:227], v[200:215]
  buffer_load_dwordx4 v11, s[76:79], s59 offen offset:1024 lds
  ds_read_b128 a[204:207], v28 offset:1024
  ds_read_b128 a[208:211], v32 offset:0
  ds_read_b64_tr_b16 a[196:197], v23 offset:16384
  v_mfma_f32_16x16x32_bf16 v[36:39], a[212:215], a[228:231], v[36:39]
  ds_read_b64_tr_b16 a[198:199], v23 offset:17408
  v_mfma_f32_32x32x16_bf16 v[184:199], a[216:219], a[220:223], v[184:199]
  buffer_load_dwordx4 v12, s[76:79], s59 offen offset:2048 lds
  v_exp_f32 v129, v129
  v_fma_f32 v131, v131, s31, -v237
  v_mfma_f32_32x32x16_bf16 v[216:231], a[216:219], a[224:227], v[216:231]
  v_exp_f32 v130, v130
  v_exp_f32 v131, v131
  v_add_f32 v240, v240, v124
  v_add_f32 v240, v240, v125
  v_mfma_f32_16x16x32_bf16 v[40:43], a[216:219], a[228:231], v[40:43]
  ds_read_b64_tr_b16 a[212:213], v22 offset:18432
  s_waitcnt lgkmcnt(8)
  v_mfma_f32_32x32x16_bf16 v[168:183], a[232:235], a[240:243], v[168:183]
  buffer_load_dwordx4 v13, s[76:79], s59 offen offset:3072 lds
  ds_read_b64_tr_b16 a[214:215], v22 offset:19456
  ds_read_b128 a[220:223], v28 offset:2048
  ds_read_b128 a[224:227], v28 offset:3072
  v_mfma_f32_32x32x16_bf16 v[200:215], a[232:235], a[244:247], v[200:215]
  ds_read_b128 a[228:231], v32 offset:512
  ds_read_b64_tr_b16 a[216:217], v23 offset:18432
  ds_read_b64_tr_b16 a[218:219], v23 offset:19456
  v_cvt_pk_bf16_f32 v4, v124, v125
  v_add_f32 v240, v240, v126
  v_add_f32 v240, v240, v127
  v_mfma_f32_16x16x32_bf16 v[36:39], a[232:235], a[248:251], v[36:39]
  v_cvt_pk_bf16_f32 v5, v126, v127
  v_add_f32 v240, v240, v128
  v_mfma_f32_32x32x16_bf16 v[184:199], a[236:239], a[240:243], v[184:199]
  v_add_f32 v240, v240, v129
  v_cvt_pk_bf16_f32 v6, v128, v129
  v_add_f32 v240, v240, v130
  v_add_f32 v240, v240, v131
  v_cvt_pk_bf16_f32 v7, v130, v131
  v_fma_f32 v132, v132, s31, -v238
  v_mfma_f32_32x32x16_bf16 v[216:231], a[236:239], a[244:247], v[216:231]
  v_fma_f32 v133, v133, s31, -v238
  v_exp_f32 v132, v132
  v_fma_f32 v134, v134, s31, -v238
  v_mfma_f32_16x16x32_bf16 v[40:43], a[236:239], a[248:251], v[40:43]
  s_add_u32 m0, s30, 12288
  s_waitcnt vmcnt(16) lgkmcnt(7)
  v_mfma_f32_32x32x16_bf16 v[168:183], a[192:195], a[200:203], v[168:183]
  buffer_load_dwordx4 v14, s[80:83], s57 offen offset:0 lds
  ds_read_b64_tr_b16 a[232:233], v22 offset:20480
  ds_read_b64_tr_b16 a[234:235], v22 offset:21504
  ds_read_b128 a[240:243], v29 offset:0
  v_mfma_f32_32x32x16_bf16 v[200:215], a[192:195], a[204:207], v[200:215]
  buffer_load_dwordx4 v15, s[80:83], s57 offen offset:1024 lds
  ds_read_b128 a[244:247], v29 offset:1024
  ds_read_b128 a[248:251], v33 offset:0
  ds_read_b64_tr_b16 a[236:237], v23 offset:20480
  v_mfma_f32_16x16x32_bf16 v[36:39], a[192:195], a[208:211], v[36:39]
  ds_read_b64_tr_b16 a[238:239], v23 offset:21504
  v_mfma_f32_32x32x16_bf16 v[184:199], a[196:199], a[200:203], v[184:199]
  buffer_load_dwordx4 v16, s[80:83], s57 offen offset:2048 lds
  v_exp_f32 v133, v133
  v_fma_f32 v135, v135, s31, -v238
  v_mfma_f32_32x32x16_bf16 v[216:231], a[196:199], a[204:207], v[216:231]
  v_exp_f32 v134, v134
  v_exp_f32 v135, v135
  v_add_f32 v241, v241, v132
  v_add_f32 v241, v241, v133
  v_mfma_f32_16x16x32_bf16 v[40:43], a[196:199], a[208:211], v[40:43]
  ds_read_b64_tr_b16 a[192:193], v22 offset:22528
  s_waitcnt lgkmcnt(8)
  v_mfma_f32_32x32x16_bf16 v[168:183], a[212:215], a[220:223], v[168:183]
  buffer_load_dwordx4 v17, s[80:83], s57 offen offset:3072 lds
  ds_read_b64_tr_b16 a[194:195], v22 offset:23552
  ds_read_b128 a[200:203], v29 offset:2048
  ds_read_b128 a[204:207], v29 offset:3072
  v_mfma_f32_32x32x16_bf16 v[200:215], a[212:215], a[224:227], v[200:215]
  ds_read_b128 a[208:211], v33 offset:512
  ds_read_b64_tr_b16 a[196:197], v23 offset:22528
  ds_read_b64_tr_b16 a[198:199], v23 offset:23552
  s_waitcnt vmcnt(16)
  ds_read_b128 v[136:139], v18 offset:24576
  s_waitcnt lgkmcnt(13)
  ds_read_b128 v[140:143], v19 offset:24576
  v_mfma_f32_16x16x32_bf16 v[36:39], a[212:215], a[228:231], v[36:39]
  v_cvt_pk_bf16_f32 v8, v132, v133
  v_add_f32 v241, v241, v134
  v_mfma_f32_32x32x16_bf16 v[184:199], a[216:219], a[220:223], v[184:199]
  v_add_f32 v241, v241, v135
  v_cvt_pk_bf16_f32 v9, v134, v135
  ds_write_b128 v24, v[44:47] offset:20480
  s_waitcnt lgkmcnt(13)
  ds_write_b128 v24, v[48:51] offset:21504
  ds_write_b128 v24, v[52:55] offset:22528
  v_mfma_f32_32x32x16_bf16 v[216:231], a[216:219], a[224:227], v[216:231]
  s_waitcnt lgkmcnt(13)
  ds_read_b128 v[144:147], v20 offset:24576
  ds_write_b128 v24, v[4:7] offset:23552
  s_waitcnt lgkmcnt(13)
  ds_write_b64 v25, v[8:9] offset:20480
  v_mfma_f32_16x16x32_bf16 v[40:43], a[216:219], a[228:231], v[40:43]
  s_add_u32 m0, s30, 16384
  v_mfma_f32_32x32x16_bf16 v[168:183], a[232:235], a[240:243], v[168:183]
  buffer_load_dwordx4 v14, s[84:87], s57 offen offset:0 lds
  v_mfma_f32_32x32x16_bf16 v[200:215], a[232:235], a[244:247], v[200:215]
  buffer_load_dwordx4 v15, s[84:87], s57 offen offset:1024 lds
  ds_read_b128 v[148:151], v21 offset:24576
  v_mfma_f32_16x16x32_bf16 v[36:39], a[232:235], a[248:251], v[36:39]
  v_mfma_f32_32x32x16_bf16 v[184:199], a[236:239], a[240:243], v[184:199]
  buffer_load_dwordx4 v16, s[84:87], s57 offen offset:2048 lds
  v_mfma_f32_32x32x16_bf16 v[216:231], a[236:239], a[244:247], v[216:231]
  s_waitcnt vmcnt(15) lgkmcnt(13)
  ds_read_b128 v[152:155], v18 offset:0
  v_mfma_f32_16x16x32_bf16 v[40:43], a[236:239], a[248:251], v[40:43]
  s_waitcnt lgkmcnt(10)
  v_mfma_f32_32x32x16_bf16 v[168:183], a[192:195], a[200:203], v[168:183]
  buffer_load_dwordx4 v17, s[84:87], s57 offen offset:3072 lds
  v_mfma_f32_32x32x16_bf16 v[200:215], a[192:195], a[204:207], v[200:215]
  ds_read_b128 v[156:159], v19 offset:0
  v_mfma_f32_16x16x32_bf16 v[36:39], a[192:195], a[208:211], v[36:39]
  v_mfma_f32_32x32x16_bf16 v[184:199], a[196:199], a[200:203], v[184:199]
  v_mfma_f32_32x32x16_bf16 v[216:231], a[196:199], a[204:207], v[216:231]
  ds_read_b128 v[160:163], v20 offset:0
  v_mfma_f32_16x16x32_bf16 v[40:43], a[196:199], a[208:211], v[40:43]
  s_add_u32 m0, s30, 20480
  s_waitcnt lgkmcnt(4)
  s_barrier
  v_mfma_f32_32x32x16_bf16 v[100:115], v[136:139], a[0:3], 0
  buffer_load_dwordx4 v14, s[88:91], s57 offen offset:0 lds
  v_fma_f32 v64, v64, s31, -v236
  v_fma_f32 v65, v65, s31, -v236
  v_mfma_f32_32x32x16_bf16 v[116:131], v[136:139], a[64:67], 0
  buffer_load_dwordx4 v15, s[88:91], s57 offen offset:1024 lds
  ds_read_b128 v[164:167], v21 offset:0
  v_exp_f32 v64, v64
  v_mfma_f32_16x16x32_bf16 v[132:135], v[136:139], a[128:131], 0
  v_fma_f32 v66, v66, s31, -v236
  v_mfma_f32_32x32x16_bf16 v[100:115], v[140:143], a[4:7], v[100:115]
  buffer_load_dwordx4 v16, s[88:91], s57 offen offset:2048 lds
  v_exp_f32 v65, v65
  v_fma_f32 v67, v67, s31, -v236
  v_mfma_f32_32x32x16_bf16 v[116:131], v[140:143], a[68:71], v[116:131]
  s_waitcnt vmcnt(15)
  ds_read_b128 v[136:139], v18 offset:4096
  v_exp_f32 v66, v66
  v_fma_f32 v68, v68, s31, -v236
  v_mfma_f32_16x16x32_bf16 v[132:135], v[140:143], a[132:135], v[132:135]
  v_mfma_f32_32x32x16_bf16 v[100:115], v[144:147], a[8:11], v[100:115]
  buffer_load_dwordx4 v17, s[88:91], s57 offen offset:3072 lds
  v_exp_f32 v67, v67
  v_fma_f32 v69, v69, s31, -v236
  v_mfma_f32_32x32x16_bf16 v[116:131], v[144:147], a[72:75], v[116:131]
  ds_read_b128 v[140:143], v19 offset:4096
  v_exp_f32 v68, v68
  v_fma_f32 v70, v70, s31, -v236
  v_exp_f32 v69, v69
  v_mfma_f32_16x16x32_bf16 v[132:135], v[144:147], a[136:139], v[132:135]
  v_fma_f32 v71, v71, s31, -v236
  s_waitcnt lgkmcnt(6)
  v_mfma_f32_32x32x16_bf16 v[100:115], v[148:151], a[12:15], v[100:115]
  v_exp_f32 v70, v70
  v_exp_f32 v71, v71
  v_mfma_f32_32x32x16_bf16 v[116:131], v[148:151], a[76:79], v[116:131]
  ds_read_b128 v[144:147], v20 offset:4096
  v_add_f32 v239, v239, v64
  v_add_f32 v239, v239, v65
  v_mfma_f32_16x16x32_bf16 v[132:135], v[148:151], a[140:143], v[132:135]
  s_add_u32 m0, s30, 24576
  s_waitcnt lgkmcnt(6)
  v_mfma_f32_32x32x16_bf16 v[100:115], v[152:155], a[16:19], v[100:115]
  buffer_load_dwordx4 v14, s[92:95], s57 offen offset:0 lds
  v_cvt_pk_bf16_f32 v44, v64, v65
  v_add_f32 v239, v239, v66
  v_add_f32 v239, v239, v67
  v_mfma_f32_32x32x16_bf16 v[116:131], v[152:155], a[80:83], v[116:131]
  buffer_load_dwordx4 v15, s[92:95], s57 offen offset:1024 lds
  ds_read_b128 v[148:151], v21 offset:4096
  v_cvt_pk_bf16_f32 v45, v66, v67
  v_add_f32 v239, v239, v68
  v_mfma_f32_16x16x32_bf16 v[132:135], v[152:155], a[144:147], v[132:135]
  v_add_f32 v239, v239, v69
  s_waitcnt lgkmcnt(6)
  v_mfma_f32_32x32x16_bf16 v[100:115], v[156:159], a[20:23], v[100:115]
  buffer_load_dwordx4 v16, s[92:95], s57 offen offset:2048 lds
  v_cvt_pk_bf16_f32 v46, v68, v69
  v_add_f32 v239, v239, v70
  v_add_f32 v239, v239, v71
  v_mfma_f32_32x32x16_bf16 v[116:131], v[156:159], a[84:87], v[116:131]
  s_waitcnt vmcnt(15)
  ds_read_b128 v[152:155], v18 offset:8192
  v_cvt_pk_bf16_f32 v47, v70, v71
  v_fma_f32 v80, v80, s31, -v237
  v_fma_f32 v81, v81, s31, -v237
  v_mfma_f32_16x16x32_bf16 v[132:135], v[156:159], a[148:151], v[132:135]
  s_waitcnt lgkmcnt(6)
  v_mfma_f32_32x32x16_bf16 v[100:115], v[160:163], a[24:27], v[100:115]
  buffer_load_dwordx4 v17, s[92:95], s57 offen offset:3072 lds
  v_exp_f32 v80, v80
  v_fma_f32 v82, v82, s31, -v237
  v_mfma_f32_32x32x16_bf16 v[116:131], v[160:163], a[88:91], v[116:131]
  ds_read_b128 v[156:159], v19 offset:8192
  v_exp_f32 v81, v81
  v_fma_f32 v83, v83, s31, -v237
  v_exp_f32 v82, v82
  v_mfma_f32_16x16x32_bf16 v[132:135], v[160:163], a[152:155], v[132:135]
  v_fma_f32 v84, v84, s31, -v237
  s_waitcnt lgkmcnt(6)
  v_mfma_f32_32x32x16_bf16 v[100:115], v[164:167], a[28:31], v[100:115]
  v_exp_f32 v83, v83
  v_mfma_f32_32x32x16_bf16 v[116:131], v[164:167], a[92:95], v[116:131]
  ds_read_b128 v[160:163], v20 offset:8192
  v_fma_f32 v85, v85, s31, -v237
  v_exp_f32 v84, v84
  v_mfma_f32_16x16x32_bf16 v[132:135], v[164:167], a[156:159], v[132:135]
  s_add_u32 m0, s30, 0
  s_waitcnt lgkmcnt(6)
  v_mfma_f32_32x32x16_bf16 v[100:115], v[136:139], a[32:35], v[100:115]
  buffer_load_dwordx4 v14, s[80:83], s58 offen offset:0 lds
  v_fma_f32 v86, v86, s31, -v237
  v_exp_f32 v85, v85
  v_mfma_f32_32x32x16_bf16 v[116:131], v[136:139], a[96:99], v[116:131]
  buffer_load_dwordx4 v15, s[80:83], s58 offen offset:1024 lds
  ds_read_b128 v[164:167], v21 offset:8192
  v_fma_f32 v87, v87, s31, -v237
  v_mfma_f32_16x16x32_bf16 v[132:135], v[136:139], a[160:163], v[132:135]
  s_waitcnt lgkmcnt(6)
  v_mfma_f32_32x32x16_bf16 v[100:115], v[140:143], a[36:39], v[100:115]
  buffer_load_dwordx4 v16, s[80:83], s58 offen offset:2048 lds
  v_exp_f32 v86, v86
  v_mfma_f32_32x32x16_bf16 v[116:131], v[140:143], a[100:103], v[116:131]
  s_waitcnt vmcnt(15)
  ds_read_b64_tr_b16 a[212:213], v22 offset:12288
  ds_read_b64_tr_b16 a[214:215], v22 offset:13312
  ds_read_b128 a[220:223], v26 offset:20480
  ds_read_b128 a[224:227], v26 offset:21504
  ds_read_b128 a[228:231], v30 offset:20480
  v_mfma_f32_16x16x32_bf16 v[132:135], v[140:143], a[164:167], v[132:135]
  ds_read_b64_tr_b16 a[216:217], v23 offset:12288
  s_waitcnt lgkmcnt(11)
  v_mfma_f32_32x32x16_bf16 v[100:115], v[144:147], a[40:43], v[100:115]
  buffer_load_dwordx4 v17, s[80:83], s58 offen offset:3072 lds
  ds_read_b64_tr_b16 a[218:219], v23 offset:13312
  v_exp_f32 v87, v87
  v_mfma_f32_32x32x16_bf16 v[116:131], v[144:147], a[104:107], v[116:131]
  v_add_f32 v240, v240, v80
  v_add_f32 v240, v240, v81
  v_cvt_pk_bf16_f32 v48, v80, v81
  v_add_f32 v240, v240, v82
  v_add_f32 v240, v240, v83
  v_cvt_pk_bf16_f32 v49, v82, v83
  v_mfma_f32_16x16x32_bf16 v[132:135], v[144:147], a[168:171], v[132:135]
  v_add_f32 v240, v240, v84
  s_waitcnt lgkmcnt(11)
  v_mfma_f32_32x32x16_bf16 v[100:115], v[148:151], a[44:47], v[100:115]
  v_add_f32 v240, v240, v85
  v_cvt_pk_bf16_f32 v50, v84, v85
  v_add_f32 v240, v240, v86
  v_add_f32 v240, v240, v87
  v_cvt_pk_bf16_f32 v51, v86, v87
  v_fma_f32 v72, v72, s31, -v236
  v_mfma_f32_32x32x16_bf16 v[116:131], v[148:151], a[108:111], v[116:131]
  ds_read_b64_tr_b16 a[232:233], v22 offset:14336
  ds_read_b64_tr_b16 a[234:235], v22 offset:15360
  ds_read_b128 a[240:243], v26 offset:22528
  ds_read_b128 a[244:247], v26 offset:23552
  s_waitcnt lgkmcnt(13)
  ds_read_b128 a[248:251], v30 offset:20992
  v_mfma_f32_16x16x32_bf16 v[132:135], v[148:151], a[172:175], v[132:135]
  s_add_u32 m0, s30, 4096
  v_mfma_f32_32x32x16_bf16 v[100:115], v[152:155], a[48:51], v[100:115]
  buffer_load_dwordx4 v14, s[84:87], s58 offen offset:0 lds
  ds_read_b64_tr_b16 a[236:237], v23 offset:14336
  s_waitcnt lgkmcnt(13)
  ds_read_b64_tr_b16 a[238:239], v23 offset:15360
  v_mfma_f32_32x32x16_bf16 v[116:131], v[152:155], a[112:115], v[116:131]
  buffer_load_dwordx4 v15, s[84:87], s58 offen offset:1024 lds
  v_fma_f32 v73, v73, s31, -v236
  v_exp_f32 v72, v72
  v_mfma_f32_16x16x32_bf16 v[132:135], v[152:155], a[176:179], v[132:135]
  v_fma_f32 v74, v74, s31, -v236
  v_mfma_f32_32x32x16_bf16 v[100:115], v[156:159], a[52:55], v[100:115]
  buffer_load_dwordx4 v16, s[84:87], s58 offen offset:2048 lds
  v_exp_f32 v73, v73
  v_fma_f32 v75, v75, s31, -v236
  v_mfma_f32_32x32x16_bf16 v[116:131], v[156:159], a[116:119], v[116:131]
  s_waitcnt vmcnt(15)
  ds_read_b64_tr_b16 a[192:193], v22 offset:16384
  s_waitcnt lgkmcnt(13)
  ds_read_b64_tr_b16 a[194:195], v22 offset:17408
  ds_read_b128 a[200:203], v27 offset:20480
  s_waitcnt lgkmcnt(13)
  ds_read_b128 a[204:207], v27 offset:21504
  v_mfma_f32_16x16x32_bf16 v[132:135], v[156:159], a[180:183], v[132:135]
  ds_read_b128 a[208:211], v31 offset:20480
  v_mfma_f32_32x32x16_bf16 v[100:115], v[160:163], a[56:59], v[100:115]
  buffer_load_dwordx4 v17, s[84:87], s58 offen offset:3072 lds
  s_waitcnt lgkmcnt(13)
  ds_read_b64_tr_b16 a[196:197], v23 offset:16384
  ds_read_b64_tr_b16 a[198:199], v23 offset:17408
  v_mfma_f32_32x32x16_bf16 v[116:131], v[160:163], a[120:123], v[116:131]
  v_exp_f32 v74, v74
  v_fma_f32 v76, v76, s31, -v236
  v_exp_f32 v75, v75
  v_fma_f32 v77, v77, s31, -v236
  v_mfma_f32_16x16x32_bf16 v[132:135], v[160:163], a[184:187], v[132:135]
  v_mfma_f32_32x32x16_bf16 v[100:115], v[164:167], a[60:63], v[100:115]
  v_exp_f32 v76, v76
  v_fma_f32 v78, v78, s31, -v236
  v_exp_f32 v77, v77
  v_fma_f32 v79, v79, s31, -v236
  v_mfma_f32_32x32x16_bf16 v[116:131], v[164:167], a[124:127], v[116:131]
  v_exp_f32 v78, v78
  v_exp_f32 v79, v79
  v_add_f32 v239, v239, v72
  v_add_f32 v239, v239, v73
  v_mfma_f32_16x16x32_bf16 v[132:135], v[164:167], a[188:191], v[132:135]
  s_add_u32 m0, s30, 8192
  s_waitcnt lgkmcnt(14)
  v_mfma_f32_32x32x16_bf16 v[168:183], a[212:215], a[220:223], v[168:183]
  buffer_load_dwordx4 v14, s[88:91], s58 offen offset:0 lds
  v_cvt_pk_bf16_f32 v52, v72, v73
  v_add_f32 v239, v239, v74
  v_add_f32 v239, v239, v75
  v_mfma_f32_32x32x16_bf16 v[200:215], a[212:215], a[224:227], v[200:215]
  buffer_load_dwordx4 v15, s[88:91], s58 offen offset:1024 lds
  v_cvt_pk_bf16_f32 v53, v74, v75
  v_add_f32 v239, v239, v76
  v_add_f32 v239, v239, v77
  v_mfma_f32_16x16x32_bf16 v[36:39], a[212:215], a[228:231], v[36:39]
  v_cvt_pk_bf16_f32 v54, v76, v77
  v_add_f32 v239, v239, v78
  v_mfma_f32_32x32x16_bf16 v[184:199], a[216:219], a[220:223], v[184:199]
  buffer_load_dwordx4 v16, s[88:91], s58 offen offset:2048 lds
  v_add_f32 v239, v239, v79
  v_cvt_pk_bf16_f32 v55, v78, v79
  v_fma_f32 v88, v88, s31, -v237
  v_mfma_f32_32x32x16_bf16 v[216:231], a[216:219], a[224:227], v[216:231]
  v_fma_f32 v89, v89, s31, -v237
  v_exp_f32 v88, v88
  v_mfma_f32_16x16x32_bf16 v[40:43], a[216:219], a[228:231], v[40:43]
  ds_read_b64_tr_b16 a[212:213], v22 offset:18432
  s_waitcnt lgkmcnt(8)
  v_mfma_f32_32x32x16_bf16 v[168:183], a[232:235], a[240:243], v[168:183]
  buffer_load_dwordx4 v17, s[88:91], s58 offen offset:3072 lds
  ds_read_b64_tr_b16 a[214:215], v22 offset:19456
  ds_read_b128 a[220:223], v27 offset:22528
  ds_read_b128 a[224:227], v27 offset:23552
  v_mfma_f32_32x32x16_bf16 v[200:215], a[232:235], a[244:247], v[200:215]
  ds_read_b128 a[228:231], v31 offset:20992
  ds_read_b64_tr_b16 a[216:217], v23 offset:18432
  ds_read_b64_tr_b16 a[218:219], v23 offset:19456
  v_fma_f32 v90, v90, s31, -v237
  v_exp_f32 v89, v89
  v_mfma_f32_16x16x32_bf16 v[36:39], a[232:235], a[248:251], v[36:39]
  v_fma_f32 v91, v91, s31, -v237
  v_mfma_f32_32x32x16_bf16 v[184:199], a[236:239], a[240:243], v[184:199]
  v_exp_f32 v90, v90
  v_fma_f32 v92, v92, s31, -v237
  v_exp_f32 v91, v91
  v_fma_f32 v93, v93, s31, -v237
  v_mfma_f32_32x32x16_bf16 v[216:231], a[236:239], a[244:247], v[216:231]
  v_exp_f32 v92, v92
  v_fma_f32 v94, v94, s31, -v237
  v_mfma_f32_16x16x32_bf16 v[40:43], a[236:239], a[248:251], v[40:43]
  s_add_u32 m0, s30, 12288
  s_waitcnt vmcnt(16) lgkmcnt(7)
  v_mfma_f32_32x32x16_bf16 v[168:183], a[192:195], a[200:203], v[168:183]
  buffer_load_dwordx4 v14, s[92:95], s58 offen offset:0 lds
  ds_read_b64_tr_b16 a[232:233], v22 offset:20480
  ds_read_b64_tr_b16 a[234:235], v22 offset:21504
  ds_read_b128 a[240:243], v28 offset:20480
  v_mfma_f32_32x32x16_bf16 v[200:215], a[192:195], a[204:207], v[200:215]
  buffer_load_dwordx4 v15, s[92:95], s58 offen offset:1024 lds
  ds_read_b128 a[244:247], v28 offset:21504
  ds_read_b128 a[248:251], v32 offset:20480
  ds_read_b64_tr_b16 a[236:237], v23 offset:20480
  v_mfma_f32_16x16x32_bf16 v[36:39], a[192:195], a[208:211], v[36:39]
  ds_read_b64_tr_b16 a[238:239], v23 offset:21504
  v_mfma_f32_32x32x16_bf16 v[184:199], a[196:199], a[200:203], v[184:199]
  buffer_load_dwordx4 v16, s[92:95], s58 offen offset:2048 lds
  v_exp_f32 v93, v93
  v_fma_f32 v95, v95, s31, -v237
  v_mfma_f32_32x32x16_bf16 v[216:231], a[196:199], a[204:207], v[216:231]
  v_exp_f32 v94, v94
  v_exp_f32 v95, v95
  v_add_f32 v240, v240, v88
  v_add_f32 v240, v240, v89
  v_mfma_f32_16x16x32_bf16 v[40:43], a[196:199], a[208:211], v[40:43]
  ds_read_b64_tr_b16 a[192:193], v22 offset:22528
  s_waitcnt lgkmcnt(8)
  v_mfma_f32_32x32x16_bf16 v[168:183], a[212:215], a[220:223], v[168:183]
  buffer_load_dwordx4 v17, s[92:95], s58 offen offset:3072 lds
  ds_read_b64_tr_b16 a[194:195], v22 offset:23552
  ds_read_b128 a[200:203], v28 offset:22528
  ds_read_b128 a[204:207], v28 offset:23552
  v_mfma_f32_32x32x16_bf16 v[200:215], a[212:215], a[224:227], v[200:215]
  ds_read_b128 a[208:211], v32 offset:20992
  ds_read_b64_tr_b16 a[196:197], v23 offset:22528
  ds_read_b64_tr_b16 a[198:199], v23 offset:23552
  v_cvt_pk_bf16_f32 v4, v88, v89
  v_add_f32 v240, v240, v90
  v_add_f32 v240, v240, v91
  v_mfma_f32_16x16x32_bf16 v[36:39], a[212:215], a[228:231], v[36:39]
  v_cvt_pk_bf16_f32 v5, v90, v91
  v_add_f32 v240, v240, v92
  v_mfma_f32_32x32x16_bf16 v[184:199], a[216:219], a[220:223], v[184:199]
  v_add_f32 v240, v240, v93
  v_cvt_pk_bf16_f32 v6, v92, v93
  v_add_f32 v240, v240, v94
  v_add_f32 v240, v240, v95
  v_cvt_pk_bf16_f32 v7, v94, v95
  v_fma_f32 v96, v96, s31, -v238
  v_mfma_f32_32x32x16_bf16 v[216:231], a[216:219], a[224:227], v[216:231]
  v_fma_f32 v97, v97, s31, -v238
  v_exp_f32 v96, v96
  v_fma_f32 v98, v98, s31, -v238
  v_mfma_f32_16x16x32_bf16 v[40:43], a[216:219], a[228:231], v[40:43]
  s_add_u32 m0, s30, 16384
  s_waitcnt vmcnt(16) lgkmcnt(7)
  v_mfma_f32_32x32x16_bf16 v[168:183], a[232:235], a[240:243], v[168:183]
  buffer_load_dwordx4 v14, s[80:83], s59 offen offset:0 lds
  ds_read_b64_tr_b16 a[212:213], v22 offset:24576
  ds_read_b64_tr_b16 a[214:215], v22 offset:25600
  ds_read_b128 a[220:223], v29 offset:20480
  v_mfma_f32_32x32x16_bf16 v[200:215], a[232:235], a[244:247], v[200:215]
  buffer_load_dwordx4 v15, s[80:83], s59 offen offset:1024 lds
  ds_read_b128 a[224:227], v29 offset:21504
  ds_read_b128 a[228:231], v33 offset:20480
  ds_read_b64_tr_b16 a[216:217], v23 offset:24576
  v_mfma_f32_16x16x32_bf16 v[36:39], a[232:235], a[248:251], v[36:39]
  ds_read_b64_tr_b16 a[218:219], v23 offset:25600
  v_mfma_f32_32x32x16_bf16 v[184:199], a[236:239], a[240:243], v[184:199]
  buffer_load_dwordx4 v16, s[80:83], s59 offen offset:2048 lds
  v_exp_f32 v97, v97
  v_fma_f32 v99, v99, s31, -v238
  v_mfma_f32_32x32x16_bf16 v[216:231], a[236:239], a[244:247], v[216:231]
  v_exp_f32 v98, v98
  v_exp_f32 v99, v99
  v_add_f32 v241, v241, v96
  v_add_f32 v241, v241, v97
  v_mfma_f32_16x16x32_bf16 v[40:43], a[236:239], a[248:251], v[40:43]
  ds_read_b64_tr_b16 a[232:233], v22 offset:26624
  s_waitcnt lgkmcnt(8)
  v_mfma_f32_32x32x16_bf16 v[168:183], a[192:195], a[200:203], v[168:183]
  buffer_load_dwordx4 v17, s[80:83], s59 offen offset:3072 lds
  ds_read_b64_tr_b16 a[234:235], v22 offset:27648
  ds_read_b128 a[240:243], v29 offset:22528
  ds_read_b128 a[244:247], v29 offset:23552
  v_mfma_f32_32x32x16_bf16 v[200:215], a[192:195], a[204:207], v[200:215]
  ds_read_b128 a[248:251], v33 offset:20992
  ds_read_b64_tr_b16 a[236:237], v23 offset:26624
  ds_read_b64_tr_b16 a[238:239], v23 offset:27648
  v_cvt_pk_bf16_f32 v8, v96, v97
  v_add_f32 v241, v241, v98
  v_add_f32 v241, v241, v99
  v_mfma_f32_16x16x32_bf16 v[36:39], a[192:195], a[208:211], v[36:39]
  v_cvt_pk_bf16_f32 v9, v98, v99
  ds_write_b128 v24, v[44:47] offset:0
  v_mfma_f32_32x32x16_bf16 v[184:199], a[196:199], a[200:203], v[184:199]
  s_waitcnt lgkmcnt(13)
  ds_write_b128 v24, v[48:51] offset:1024
  ds_write_b128 v24, v[52:55] offset:2048
  s_waitcnt lgkmcnt(13)
  ds_write_b128 v24, v[4:7] offset:3072
  ds_write_b64 v25, v[8:9] offset:0
  v_mfma_f32_32x32x16_bf16 v[216:231], a[196:199], a[204:207], v[216:231]
  v_mfma_f32_16x16x32_bf16 v[40:43], a[196:199], a[208:211], v[40:43]
  s_add_u32 m0, s30, 20480
  s_waitcnt lgkmcnt(12)
  v_mfma_f32_32x32x16_bf16 v[168:183], a[212:215], a[220:223], v[168:183]
  buffer_load_dwordx4 v14, s[84:87], s59 offen offset:0 lds
  v_mfma_f32_32x32x16_bf16 v[200:215], a[212:215], a[224:227], v[200:215]
  buffer_load_dwordx4 v15, s[84:87], s59 offen offset:1024 lds
  v_mfma_f32_16x16x32_bf16 v[36:39], a[212:215], a[228:231], v[36:39]
  v_mfma_f32_32x32x16_bf16 v[184:199], a[216:219], a[220:223], v[184:199]
  buffer_load_dwordx4 v16, s[84:87], s59 offen offset:2048 lds
  v_mfma_f32_32x32x16_bf16 v[216:231], a[216:219], a[224:227], v[216:231]
  v_mfma_f32_16x16x32_bf16 v[40:43], a[216:219], a[228:231], v[40:43]
  s_waitcnt lgkmcnt(5)
  v_mfma_f32_32x32x16_bf16 v[168:183], a[232:235], a[240:243], v[168:183]
  buffer_load_dwordx4 v17, s[84:87], s59 offen offset:3072 lds
  v_mfma_f32_32x32x16_bf16 v[200:215], a[232:235], a[244:247], v[200:215]
  v_mfma_f32_16x16x32_bf16 v[36:39], a[232:235], a[248:251], v[36:39]
  v_mfma_f32_32x32x16_bf16 v[184:199], a[236:239], a[240:243], v[184:199]
  v_mfma_f32_32x32x16_bf16 v[216:231], a[236:239], a[244:247], v[216:231]
  v_mfma_f32_16x16x32_bf16 v[40:43], a[236:239], a[248:251], v[40:43]
  s_add_u32 m0, s30, 24576
  s_waitcnt lgkmcnt(0)
  s_barrier
  s_waitcnt vmcnt(20)
  ds_read_b64_tr_b16 a[192:193], v22 offset:0
  ds_read_b64_tr_b16 a[194:195], v22 offset:1024
  ds_read_b128 a[200:203], v26 offset:0
  ds_read_b128 a[204:207], v26 offset:1024
  ds_read_b128 a[208:211], v30 offset:0
  ds_read_b64_tr_b16 a[196:197], v23 offset:0
  ds_read_b64_tr_b16 a[198:199], v23 offset:1024
  s_waitcnt lgkmcnt(0)
  v_mfma_f32_32x32x16_bf16 v[168:183], a[192:195], a[200:203], v[168:183]
  buffer_load_dwordx4 v14, s[88:91], s59 offen offset:0 lds
  ds_read_b64_tr_b16 a[212:213], v22 offset:2048
  ds_read_b64_tr_b16 a[214:215], v22 offset:3072
  ds_read_b128 a[220:223], v26 offset:2048
  v_mfma_f32_32x32x16_bf16 v[200:215], a[192:195], a[204:207], v[200:215]
  buffer_load_dwordx4 v15, s[88:91], s59 offen offset:1024 lds
  ds_read_b128 a[224:227], v26 offset:3072
  ds_read_b128 a[228:231], v30 offset:512
  ds_read_b64_tr_b16 a[216:217], v23 offset:2048
  v_mfma_f32_16x16x32_bf16 v[36:39], a[192:195], a[208:211], v[36:39]
  ds_read_b64_tr_b16 a[218:219], v23 offset:3072
  s_waitcnt vmcnt(18)
  ds_read_b64_tr_b16 a[232:233], v22 offset:4096
  v_mfma_f32_32x32x16_bf16 v[184:199], a[196:199], a[200:203], v[184:199]
  buffer_load_dwordx4 v16, s[88:91], s59 offen offset:2048 lds
  ds_read_b64_tr_b16 a[234:235], v22 offset:5120
  ds_read_b128 a[240:243], v27 offset:0
  ds_read_b128 a[244:247], v27 offset:1024
  v_mfma_f32_32x32x16_bf16 v[216:231], a[196:199], a[204:207], v[216:231]
  ds_read_b128 a[248:251], v31 offset:0
  ds_read_b64_tr_b16 a[236:237], v23 offset:4096
  ds_read_b64_tr_b16 a[238:239], v23 offset:5120
  v_fma_f32 v100, v100, s31, -v236
  v_fma_f32 v101, v101, s31, -v236
  v_mfma_f32_16x16x32_bf16 v[40:43], a[196:199], a[208:211], v[40:43]
  ds_read_b64_tr_b16 a[192:193], v22 offset:6144
  s_waitcnt lgkmcnt(8)
  v_mfma_f32_32x32x16_bf16 v[168:183], a[212:215], a[220:223], v[168:183]
  buffer_load_dwordx4 v17, s[88:91], s59 offen offset:3072 lds
  ds_read_b64_tr_b16 a[194:195], v22 offset:7168
  ds_read_b128 a[200:203], v27 offset:2048
  ds_read_b128 a[204:207], v27 offset:3072
  v_mfma_f32_32x32x16_bf16 v[200:215], a[212:215], a[224:227], v[200:215]
  ds_read_b128 a[208:211], v31 offset:512
  ds_read_b64_tr_b16 a[196:197], v23 offset:6144
  ds_read_b64_tr_b16 a[198:199], v23 offset:7168
  v_exp_f32 v100, v100
  v_fma_f32 v102, v102, s31, -v236
  v_mfma_f32_16x16x32_bf16 v[36:39], a[212:215], a[228:231], v[36:39]
  v_exp_f32 v101, v101
  v_mfma_f32_32x32x16_bf16 v[184:199], a[216:219], a[220:223], v[184:199]
  v_fma_f32 v103, v103, s31, -v236
  v_exp_f32 v102, v102
  v_fma_f32 v104, v104, s31, -v236
  v_exp_f32 v103, v103
  v_mfma_f32_32x32x16_bf16 v[216:231], a[216:219], a[224:227], v[216:231]
  v_fma_f32 v105, v105, s31, -v236
  v_exp_f32 v104, v104
  v_fma_f32 v106, v106, s31, -v236
  v_exp_f32 v105, v105
  v_mfma_f32_16x16x32_bf16 v[40:43], a[216:219], a[228:231], v[40:43]
  s_add_u32 m0, s30, 0
  s_waitcnt vmcnt(16) lgkmcnt(7)
  v_mfma_f32_32x32x16_bf16 v[168:183], a[232:235], a[240:243], v[168:183]
  buffer_load_dwordx4 v14, s[92:95], s59 offen offset:0 lds
  ds_read_b64_tr_b16 a[212:213], v22 offset:8192
  ds_read_b64_tr_b16 a[214:215], v22 offset:9216
  ds_read_b128 a[220:223], v28 offset:0
  v_mfma_f32_32x32x16_bf16 v[200:215], a[232:235], a[244:247], v[200:215]
  buffer_load_dwordx4 v15, s[92:95], s59 offen offset:1024 lds
  ds_read_b128 a[224:227], v28 offset:1024
  ds_read_b128 a[228:231], v32 offset:0
  ds_read_b64_tr_b16 a[216:217], v23 offset:8192
  v_mfma_f32_16x16x32_bf16 v[36:39], a[232:235], a[248:251], v[36:39]
  ds_read_b64_tr_b16 a[218:219], v23 offset:9216
  v_fma_f32 v107, v107, s31, -v236
  v_mfma_f32_32x32x16_bf16 v[184:199], a[236:239], a[240:243], v[184:199]
  buffer_load_dwordx4 v16, s[92:95], s59 offen offset:2048 lds
  v_exp_f32 v106, v106
  v_mfma_f32_32x32x16_bf16 v[216:231], a[236:239], a[244:247], v[216:231]
  v_exp_f32 v107, v107
  v_add_f32 v239, v239, v100
  v_add_f32 v239, v239, v101
  v_cvt_pk_bf16_f32 v44, v100, v101
  v_add_f32 v239, v239, v102
  v_mfma_f32_16x16x32_bf16 v[40:43], a[236:239], a[248:251], v[40:43]
  ds_read_b64_tr_b16 a[232:233], v22 offset:10240
  s_waitcnt lgkmcnt(8)
  v_mfma_f32_32x32x16_bf16 v[168:183], a[192:195], a[200:203], v[168:183]
  buffer_load_dwordx4 v17, s[92:95], s59 offen offset:3072 lds
  ds_read_b64_tr_b16 a[234:235], v22 offset:11264
  ds_read_b128 a[240:243], v28 offset:2048
  ds_read_b128 a[244:247], v28 offset:3072
  v_mfma_f32_32x32x16_bf16 v[200:215], a[192:195], a[204:207], v[200:215]
  ds_read_b128 a[248:251], v32 offset:512
  ds_read_b64_tr_b16 a[236:237], v23 offset:10240
  ds_read_b64_tr_b16 a[238:239], v23 offset:11264
  v_add_f32 v239, v239, v103
  v_cvt_pk_bf16_f32 v45, v102, v103
  v_add_f32 v239, v239, v104
  v_mfma_f32_16x16x32_bf16 v[36:39], a[192:195], a[208:211], v[36:39]
  v_add_f32 v239, v239, v105
  v_cvt_pk_bf16_f32 v46, v104, v105
  v_mfma_f32_32x32x16_bf16 v[184:199], a[196:199], a[200:203], v[184:199]
  v_add_f32 v239, v239, v106
  v_add_f32 v239, v239, v107
  v_cvt_pk_bf16_f32 v47, v106, v107
  v_fma_f32 v116, v116, s31, -v237
  v_fma_f32 v117, v117, s31, -v237
  v_mfma_f32_32x32x16_bf16 v[216:231], a[196:199], a[204:207], v[216:231]
  v_exp_f32 v116, v116
  v_fma_f32 v118, v118, s31, -v237
  v_exp_f32 v117, v117
  v_fma_f32 v119, v119, s31, -v237
  v_mfma_f32_16x16x32_bf16 v[40:43], a[196:199], a[208:211], v[40:43]
  s_waitcnt vmcnt(16)
  ds_read_b64_tr_b16 a[192:193], v22 offset:12288
  s_waitcnt lgkmcnt(8)
  v_mfma_f32_32x32x16_bf16 v[168:183], a[212:215], a[220:223], v[168:183]
  ds_read_b64_tr_b16 a[194:195], v22 offset:13312
  ds_read_b128 a[200:203], v29 offset:0
  ds_read_b128 a[204:207], v29 offset:1024
  ds_read_b128 a[208:211], v33 offset:0
  ds_read_b64_tr_b16 a[196:197], v23 offset:12288
  ds_read_b64_tr_b16 a[198:199], v23 offset:13312
  v_mfma_f32_32x32x16_bf16 v[200:215], a[212:215], a[224:227], v[200:215]
  v_exp_f32 v118, v118
  v_fma_f32 v120, v120, s31, -v237
  v_exp_f32 v119, v119
  v_fma_f32 v121, v121, s31, -v237
  v_mfma_f32_16x16x32_bf16 v[36:39], a[212:215], a[228:231], v[36:39]
  v_exp_f32 v120, v120
  v_mfma_f32_32x32x16_bf16 v[184:199], a[216:219], a[220:223], v[184:199]
  v_fma_f32 v122, v122, s31, -v237
  v_exp_f32 v121, v121
  v_fma_f32 v123, v123, s31, -v237
  v_exp_f32 v122, v122
  v_mfma_f32_32x32x16_bf16 v[216:231], a[216:219], a[224:227], v[216:231]
  v_exp_f32 v123, v123
  v_add_f32 v240, v240, v116
  v_add_f32 v240, v240, v117
  v_cvt_pk_bf16_f32 v48, v116, v117
  v_add_f32 v240, v240, v118
  v_mfma_f32_16x16x32_bf16 v[40:43], a[216:219], a[228:231], v[40:43]
  ds_read_b64_tr_b16 a[212:213], v22 offset:14336
  s_waitcnt lgkmcnt(8)
  v_mfma_f32_32x32x16_bf16 v[168:183], a[232:235], a[240:243], v[168:183]
  ds_read_b64_tr_b16 a[214:215], v22 offset:15360
  ds_read_b128 a[220:223], v29 offset:2048
  ds_read_b128 a[224:227], v29 offset:3072
  ds_read_b128 a[228:231], v33 offset:512
  ds_read_b64_tr_b16 a[216:217], v23 offset:14336
  ds_read_b64_tr_b16 a[218:219], v23 offset:15360
  v_mfma_f32_32x32x16_bf16 v[200:215], a[232:235], a[244:247], v[200:215]
  v_add_f32 v240, v240, v119
  v_cvt_pk_bf16_f32 v49, v118, v119
  v_add_f32 v240, v240, v120
  v_add_f32 v240, v240, v121
  v_cvt_pk_bf16_f32 v50, v120, v121
  v_add_f32 v240, v240, v122
  v_mfma_f32_16x16x32_bf16 v[36:39], a[232:235], a[248:251], v[36:39]
  v_add_f32 v240, v240, v123
  v_cvt_pk_bf16_f32 v51, v122, v123
  v_mfma_f32_32x32x16_bf16 v[184:199], a[236:239], a[240:243], v[184:199]
  v_fma_f32 v108, v108, s31, -v236
  v_fma_f32 v109, v109, s31, -v236
  v_exp_f32 v108, v108
  v_fma_f32 v110, v110, s31, -v236
  v_mfma_f32_32x32x16_bf16 v[216:231], a[236:239], a[244:247], v[216:231]
  v_exp_f32 v109, v109
  v_fma_f32 v111, v111, s31, -v236
  v_exp_f32 v110, v110
  v_fma_f32 v112, v112, s31, -v236
  v_mfma_f32_16x16x32_bf16 v[40:43], a[236:239], a[248:251], v[40:43]
  s_waitcnt lgkmcnt(7)
  v_mfma_f32_32x32x16_bf16 v[168:183], a[192:195], a[200:203], v[168:183]
  v_exp_f32 v111, v111
  v_fma_f32 v113, v113, s31, -v236
  v_exp_f32 v112, v112
  v_fma_f32 v114, v114, s31, -v236
  v_mfma_f32_32x32x16_bf16 v[200:215], a[192:195], a[204:207], v[200:215]
  v_exp_f32 v113, v113
  v_fma_f32 v115, v115, s31, -v236
  v_exp_f32 v114, v114
  v_mfma_f32_16x16x32_bf16 v[36:39], a[192:195], a[208:211], v[36:39]
  v_exp_f32 v115, v115
  v_mfma_f32_32x32x16_bf16 v[184:199], a[196:199], a[200:203], v[184:199]
  v_add_f32 v239, v239, v108
  v_add_f32 v239, v239, v109
  v_cvt_pk_bf16_f32 v52, v108, v109
  v_add_f32 v239, v239, v110
  v_add_f32 v239, v239, v111
  v_cvt_pk_bf16_f32 v53, v110, v111
  v_mfma_f32_32x32x16_bf16 v[216:231], a[196:199], a[204:207], v[216:231]
  v_add_f32 v239, v239, v112
  v_add_f32 v239, v239, v113
  v_cvt_pk_bf16_f32 v54, v112, v113
  v_add_f32 v239, v239, v114
  v_add_f32 v239, v239, v115
  v_cvt_pk_bf16_f32 v55, v114, v115
  v_mfma_f32_16x16x32_bf16 v[40:43], a[196:199], a[208:211], v[40:43]
  v_fma_f32 v124, v124, s31, -v237
  s_waitcnt lgkmcnt(0)
  v_mfma_f32_32x32x16_bf16 v[168:183], a[212:215], a[220:223], v[168:183]
  v_fma_f32 v125, v125, s31, -v237
  v_exp_f32 v124, v124
  v_fma_f32 v126, v126, s31, -v237
  v_exp_f32 v125, v125
  v_mfma_f32_32x32x16_bf16 v[200:215], a[212:215], a[224:227], v[200:215]
  v_fma_f32 v127, v127, s31, -v237
  v_exp_f32 v126, v126
  v_fma_f32 v128, v128, s31, -v237
  v_exp_f32 v127, v127
  v_mfma_f32_16x16x32_bf16 v[36:39], a[212:215], a[228:231], v[36:39]
  v_fma_f32 v129, v129, s31, -v237
  v_mfma_f32_32x32x16_bf16 v[184:199], a[216:219], a[220:223], v[184:199]
  v_exp_f32 v128, v128
  v_fma_f32 v130, v130, s31, -v237
  v_exp_f32 v129, v129
  v_fma_f32 v131, v131, s31, -v237
  v_mfma_f32_32x32x16_bf16 v[216:231], a[216:219], a[224:227], v[216:231]
  v_exp_f32 v130, v130
  v_exp_f32 v131, v131
  v_add_f32 v240, v240, v124
  v_add_f32 v240, v240, v125
  v_mfma_f32_16x16x32_bf16 v[40:43], a[216:219], a[228:231], v[40:43]
  v_cvt_pk_bf16_f32 v4, v124, v125
  v_add_f32 v240, v240, v126
  v_add_f32 v240, v240, v127
  v_cvt_pk_bf16_f32 v5, v126, v127
  v_add_f32 v240, v240, v128
  v_add_f32 v240, v240, v129
  v_cvt_pk_bf16_f32 v6, v128, v129
  v_add_f32 v240, v240, v130
  v_add_f32 v240, v240, v131
  v_cvt_pk_bf16_f32 v7, v130, v131
  v_fma_f32 v132, v132, s31, -v238
  v_fma_f32 v133, v133, s31, -v238
  v_exp_f32 v132, v132
  v_fma_f32 v134, v134, s31, -v238
  v_exp_f32 v133, v133
  v_fma_f32 v135, v135, s31, -v238
  v_exp_f32 v134, v134
  v_exp_f32 v135, v135
  v_add_f32 v241, v241, v132
  v_add_f32 v241, v241, v133
  v_cvt_pk_bf16_f32 v8, v132, v133
  v_add_f32 v241, v241, v134
  v_add_f32 v241, v241, v135
  v_cvt_pk_bf16_f32 v9, v134, v135
  ds_write_b128 v24, v[44:47] offset:20480
  ds_write_b128 v24, v[48:51] offset:21504
  ds_write_b128 v24, v[52:55] offset:22528
  ds_write_b128 v24, v[4:7] offset:23552
  ds_write_b64 v25, v[8:9] offset:20480
  v_add_f32_dpp v244, v241, v241 row_ror:8 row_mask:0xf bank_mask:0xf
  v_mov_b32 v242, v239
  v_mov_b32 v243, v240
  v_mov_b32 v241, v244
  v_permlane32_swap_b32 v239, v242
  v_permlane32_swap_b32 v240, v243
  v_permlane16_swap_b32 v241, v244
  v_add_f32 v239, v239, v242
  v_add_f32 v240, v240, v243
  v_add_f32 v241, v241, v244
  v_mov_b32 v244, v241
  s_nop 1
  v_permlane32_swap_b32 v241, v244
  v_add_f32 v241, v241, v244
  ds_write_b32 v56, v239 offset:1280
  ds_write_b32 v56, v240 offset:1792
  ds_write_b32 v57, v241 offset:1280
  s_waitcnt lgkmcnt(0)
  s_barrier
  s_waitcnt vmcnt(12)
  ds_read_b64_tr_b16 a[232:233], v22 offset:16384
  ds_read_b64_tr_b16 a[234:235], v22 offset:17408
  ds_read_b128 a[240:243], v26 offset:20480
  ds_read_b128 a[244:247], v26 offset:21504
  ds_read_b128 a[248:251], v30 offset:20480
  ds_read_b64_tr_b16 a[236:237], v23 offset:16384
  ds_read_b64_tr_b16 a[238:239], v23 offset:17408
  s_waitcnt lgkmcnt(0)
  v_mfma_f32_32x32x16_bf16 v[168:183], a[232:235], a[240:243], v[168:183]
  ds_read_b64_tr_b16 a[192:193], v22 offset:18432
  ds_read_b64_tr_b16 a[194:195], v22 offset:19456
  ds_read_b128 a[200:203], v26 offset:22528
  ds_read_b128 a[204:207], v26 offset:23552
  ds_read_b128 a[208:211], v30 offset:20992
  ds_read_b64_tr_b16 a[196:197], v23 offset:18432
  v_mfma_f32_32x32x16_bf16 v[200:215], a[232:235], a[244:247], v[200:215]
  ds_read_b64_tr_b16 a[198:199], v23 offset:19456
  s_waitcnt vmcnt(8)
  ds_read_b64_tr_b16 a[212:213], v22 offset:20480
  ds_read_b64_tr_b16 a[214:215], v22 offset:21504
  ds_read_b128 a[220:223], v27 offset:20480
  ds_read_b128 a[224:227], v27 offset:21504
  v_mfma_f32_16x16x32_bf16 v[36:39], a[232:235], a[248:251], v[36:39]
  ds_read_b128 a[228:231], v31 offset:20480
  ds_read_b64_tr_b16 a[216:217], v23 offset:20480
  v_mfma_f32_32x32x16_bf16 v[184:199], a[236:239], a[240:243], v[184:199]
  ds_read_b64_tr_b16 a[218:219], v23 offset:21504
  ds_read_b128 v[100:103], v58 offset:1280
  s_waitcnt lgkmcnt(13)
  ds_read_b128 v[104:107], v58 offset:1792
  ds_read_b128 v[108:111], v59 offset:1280
  v_and_b32 v64, 31, v2
  v_mfma_f32_32x32x16_bf16 v[216:231], a[236:239], a[244:247], v[216:231]
  v_mul_u32_u24 v64, 144, v64
  v_lshrrev_b32 v65, 5, v2
  v_lshl_add_u32 v64, v65, 3, v64
  v_add_u32 v64, s30, v64
  v_and_b32 v65, 7, v2
  v_mul_u32_u24 v65, 144, v65
  v_mfma_f32_16x16x32_bf16 v[40:43], a[236:239], a[248:251], v[40:43]
  s_waitcnt lgkmcnt(13)
  ds_read_b64_tr_b16 a[232:233], v22 offset:22528
  s_waitcnt lgkmcnt(11)
  v_mfma_f32_32x32x16_bf16 v[168:183], a[192:195], a[200:203], v[168:183]
  ds_read_b64_tr_b16 a[234:235], v22 offset:23552
  ds_read_b128 a[240:243], v27 offset:22528
  ds_read_b128 a[244:247], v27 offset:23552
  ds_read_b128 a[248:251], v31 offset:20992
  s_waitcnt lgkmcnt(13)
  ds_read_b64_tr_b16 a[236:237], v23 offset:22528
  v_mfma_f32_32x32x16_bf16 v[200:215], a[192:195], a[204:207], v[200:215]
  ds_read_b64_tr_b16 a[238:239], v23 offset:23552
  v_bfe_u32 v66, v2, 3, 1
  v_lshl_add_u32 v65, v66, 5, v65
  v_lshrrev_b32 v66, 4, v2
  v_lshl_add_u32 v65, v66, 3, v65
  v_add_u32 v65, s30, v65
  v_mfma_f32_16x16x32_bf16 v[36:39], a[192:195], a[208:211], v[36:39]
  v_lshrrev_b32 v68, 3, v2
  v_and_b32 v69, 7, v2
  v_mfma_f32_32x32x16_bf16 v[184:199], a[196:199], a[200:203], v[184:199]
  v_mul_u32_u24 v66, 144, v68
  v_lshl_add_u32 v66, v69, 4, v66
  v_add_u32 v66, s30, v66
  v_lshlrev_b32 v67, 9, v68
  v_lshl_add_u32 v67, v69, 4, v67
  s_lshl_b32 s34, s28, 7
  v_mfma_f32_32x32x16_bf16 v[216:231], a[196:199], a[204:207], v[216:231]
  v_add_u32 v67, s34, v67
  s_waitcnt lgkmcnt(9)
  v_add_f32 v239, v100, v101
  v_add_f32 v102, v102, v103
  s_waitcnt lgkmcnt(8)
  v_add_f32 v240, v104, v105
  v_mfma_f32_16x16x32_bf16 v[40:43], a[196:199], a[208:211], v[40:43]
  s_waitcnt vmcnt(4)
  ds_read_b64_tr_b16 a[192:193], v22 offset:24576
  v_mfma_f32_32x32x16_bf16 v[168:183], a[212:215], a[220:223], v[168:183]
  ds_read_b64_tr_b16 a[194:195], v22 offset:25600
  ds_read_b128 a[200:203], v28 offset:20480
  ds_read_b128 a[204:207], v28 offset:21504
  ds_read_b128 a[208:211], v32 offset:20480
  ds_read_b64_tr_b16 a[196:197], v23 offset:24576
  ds_read_b64_tr_b16 a[198:199], v23 offset:25600
  v_mfma_f32_32x32x16_bf16 v[200:215], a[212:215], a[224:227], v[200:215]
  v_add_f32 v106, v106, v107
  s_waitcnt lgkmcnt(14)
  v_add_f32 v241, v108, v109
  v_add_f32 v110, v110, v111
  v_add_f32 v239, v239, v102
  v_add_f32 v240, v240, v106
  v_mfma_f32_16x16x32_bf16 v[36:39], a[212:215], a[228:231], v[36:39]
  v_add_f32 v241, v241, v110
  v_add_f32 v242, v239, v240
  v_mfma_f32_32x32x16_bf16 v[184:199], a[216:219], a[220:223], v[184:199]
  v_add_f32 v242, v242, v241
  v_cmp_gt_f32 vcc, 0x5f800000, v242
  v_rcp_f32 v239, v239
  v_rcp_f32 v240, v240
  v_mfma_f32_32x32x16_bf16 v[216:231], a[216:219], a[224:227], v[216:231]
  v_rcp_f32 v241, v241
  v_mfma_f32_16x16x32_bf16 v[40:43], a[216:219], a[228:231], v[40:43]
  ds_read_b64_tr_b16 a[212:213], v22 offset:26624
  s_waitcnt lgkmcnt(8)
  v_mfma_f32_32x32x16_bf16 v[168:183], a[232:235], a[240:243], v[168:183]
  ds_read_b64_tr_b16 a[214:215], v22 offset:27648
  ds_read_b128 a[220:223], v28 offset:22528
  ds_read_b128 a[224:227], v28 offset:23552
  ds_read_b128 a[228:231], v32 offset:20992
  ds_read_b64_tr_b16 a[216:217], v23 offset:26624
  ds_read_b64_tr_b16 a[218:219], v23 offset:27648
  v_mfma_f32_32x32x16_bf16 v[200:215], a[232:235], a[244:247], v[200:215]
  v_mfma_f32_16x16x32_bf16 v[36:39], a[232:235], a[248:251], v[36:39]
  v_mfma_f32_32x32x16_bf16 v[184:199], a[236:239], a[240:243], v[184:199]
  v_mfma_f32_32x32x16_bf16 v[216:231], a[236:239], a[244:247], v[216:231]
  v_mfma_f32_16x16x32_bf16 v[40:43], a[236:239], a[248:251], v[40:43]
  s_waitcnt vmcnt(0)
  ds_read_b64_tr_b16 a[232:233], v22 offset:0
  s_waitcnt lgkmcnt(8)
  v_mfma_f32_32x32x16_bf16 v[168:183], a[192:195], a[200:203], v[168:183]
  ds_read_b64_tr_b16 a[234:235], v22 offset:1024
  ds_read_b128 a[240:243], v29 offset:20480
  ds_read_b128 a[244:247], v29 offset:21504
  ds_read_b128 a[248:251], v33 offset:20480
  ds_read_b64_tr_b16 a[236:237], v23 offset:0
  ds_read_b64_tr_b16 a[238:239], v23 offset:1024
  v_mfma_f32_32x32x16_bf16 v[200:215], a[192:195], a[204:207], v[200:215]
  v_mfma_f32_16x16x32_bf16 v[36:39], a[192:195], a[208:211], v[36:39]
  v_mfma_f32_32x32x16_bf16 v[184:199], a[196:199], a[200:203], v[184:199]
  v_mfma_f32_32x32x16_bf16 v[216:231], a[196:199], a[204:207], v[216:231]
  v_mfma_f32_16x16x32_bf16 v[40:43], a[196:199], a[208:211], v[40:43]
  ds_read_b64_tr_b16 a[192:193], v22 offset:2048
  s_waitcnt lgkmcnt(8)
  v_mfma_f32_32x32x16_bf16 v[168:183], a[212:215], a[220:223], v[168:183]
  ds_read_b64_tr_b16 a[194:195], v22 offset:3072
  ds_read_b128 a[200:203], v29 offset:22528
  ds_read_b128 a[204:207], v29 offset:23552
  ds_read_b128 a[208:211], v33 offset:20992
  ds_read_b64_tr_b16 a[196:197], v23 offset:2048
  ds_read_b64_tr_b16 a[198:199], v23 offset:3072
  v_mfma_f32_32x32x16_bf16 v[200:215], a[212:215], a[224:227], v[200:215]
  v_mfma_f32_16x16x32_bf16 v[36:39], a[212:215], a[228:231], v[36:39]
  v_mfma_f32_32x32x16_bf16 v[184:199], a[216:219], a[220:223], v[184:199]
  v_mfma_f32_32x32x16_bf16 v[216:231], a[216:219], a[224:227], v[216:231]
  v_mfma_f32_16x16x32_bf16 v[40:43], a[216:219], a[228:231], v[40:43]
  s_waitcnt lgkmcnt(7)
  v_mfma_f32_32x32x16_bf16 v[168:183], a[232:235], a[240:243], v[168:183]
  v_mfma_f32_32x32x16_bf16 v[200:215], a[232:235], a[244:247], v[200:215]
  v_mfma_f32_16x16x32_bf16 v[36:39], a[232:235], a[248:251], v[36:39]
  v_mfma_f32_32x32x16_bf16 v[184:199], a[236:239], a[240:243], v[184:199]
  v_mfma_f32_32x32x16_bf16 v[216:231], a[236:239], a[244:247], v[216:231]
  v_mfma_f32_16x16x32_bf16 v[40:43], a[236:239], a[248:251], v[40:43]
  s_waitcnt lgkmcnt(0)
  v_mfma_f32_32x32x16_bf16 v[168:183], a[192:195], a[200:203], v[168:183]
  v_mfma_f32_32x32x16_bf16 v[200:215], a[192:195], a[204:207], v[200:215]
  v_mfma_f32_16x16x32_bf16 v[36:39], a[192:195], a[208:211], v[36:39]
  v_mfma_f32_32x32x16_bf16 v[184:199], a[196:199], a[200:203], v[184:199]
  v_mfma_f32_32x32x16_bf16 v[216:231], a[196:199], a[204:207], v[216:231]
  v_mfma_f32_16x16x32_bf16 v[40:43], a[196:199], a[208:211], v[40:43]
  s_cmp_lg_u32 s33, 0
  s_cbranch_scc1 L_epi_v0
  s_cmp_eq_u64 vcc, -1
  s_cbranch_scc0 L_fallback_v0
L_epi_v0:
  s_nop 2
  v_mul_f32 v168, v168, v239
  v_mul_f32 v169, v169, v239
  v_mul_f32 v170, v170, v239
  v_mul_f32 v171, v171, v239
  v_cvt_pk_bf16_f32 v72, v168, v169
  v_cvt_pk_bf16_f32 v73, v170, v171
  ds_write_b64 v64, v[72:73] offset:0
  v_mul_f32 v172, v172, v239
  v_mul_f32 v173, v173, v239
  v_mul_f32 v174, v174, v239
  v_mul_f32 v175, v175, v239
  v_cvt_pk_bf16_f32 v74, v172, v173
  v_cvt_pk_bf16_f32 v75, v174, v175
  ds_write_b64 v64, v[74:75] offset:16
  v_mul_f32 v176, v176, v239
  v_mul_f32 v177, v177, v239
  v_mul_f32 v178, v178, v239
  v_mul_f32 v179, v179, v239
  v_cvt_pk_bf16_f32 v76, v176, v177
  v_cvt_pk_bf16_f32 v77, v178, v179
  ds_write_b64 v64, v[76:77] offset:32
  v_mul_f32 v180, v180, v239
  v_mul_f32 v181, v181, v239
  v_mul_f32 v182, v182, v239
  v_mul_f32 v183, v183, v239
  v_cvt_pk_bf16_f32 v78, v180, v181
  v_cvt_pk_bf16_f32 v79, v182, v183
  ds_write_b64 v64, v[78:79] offset:48
  v_mul_f32 v200, v200, v240
  v_mul_f32 v201, v201, v240
  v_mul_f32 v202, v202, v240
  v_mul_f32 v203, v203, v240
  v_cvt_pk_bf16_f32 v80, v200, v201
  v_cvt_pk_bf16_f32 v81, v202, v203
  ds_write_b64 v64, v[80:81] offset:4608
  v_mul_f32 v204, v204, v240
  v_mul_f32 v205, v205, v240
  v_mul_f32 v206, v206, v240
  v_mul_f32 v207, v207, v240
  v_cvt_pk_bf16_f32 v82, v204, v205
  v_cvt_pk_bf16_f32 v83, v206, v207
  ds_write_b64 v64, v[82:83] offset:4624
  v_mul_f32 v208, v208, v240
  v_mul_f32 v209, v209, v240
  v_mul_f32 v210, v210, v240
  v_mul_f32 v211, v211, v240
  v_cvt_pk_bf16_f32 v84, v208, v209
  v_cvt_pk_bf16_f32 v85, v210, v211
  ds_write_b64 v64, v[84:85] offset:4640
  v_mul_f32 v212, v212, v240
  v_mul_f32 v213, v213, v240
  v_mul_f32 v214, v214, v240
  v_mul_f32 v215, v215, v240
  v_cvt_pk_bf16_f32 v86, v212, v213
  v_cvt_pk_bf16_f32 v87, v214, v215
  ds_write_b64 v64, v[86:87] offset:4656
  v_mul_f32 v184, v184, v239
  v_mul_f32 v185, v185, v239
  v_mul_f32 v186, v186, v239
  v_mul_f32 v187, v187, v239
  v_cvt_pk_bf16_f32 v72, v184, v185
  v_cvt_pk_bf16_f32 v73, v186, v187
  ds_write_b64 v64, v[72:73] offset:64
  v_mul_f32 v188, v188, v239
  v_mul_f32 v189, v189, v239
  v_mul_f32 v190, v190, v239
  v_mul_f32 v191, v191, v239
  v_cvt_pk_bf16_f32 v74, v188, v189
  v_cvt_pk_bf16_f32 v75, v190, v191
  ds_write_b64 v64, v[74:75] offset:80
  v_mul_f32 v192, v192, v239
  v_mul_f32 v193, v193, v239
  v_mul_f32 v194, v194, v239
  v_mul_f32 v195, v195, v239
  v_cvt_pk_bf16_f32 v76, v192, v193
  v_cvt_pk_bf16_f32 v77, v194, v195
  ds_write_b64 v64, v[76:77] offset:96
  v_mul_f32 v196, v196, v239
  v_mul_f32 v197, v197, v239
  v_mul_f32 v198, v198, v239
  v_mul_f32 v199, v199, v239
  v_cvt_pk_bf16_f32 v78, v196, v197
  v_cvt_pk_bf16_f32 v79, v198, v199
  ds_write_b64 v64, v[78:79] offset:112
  v_mul_f32 v216, v216, v240
  v_mul_f32 v217, v217, v240
  v_mul_f32 v218, v218, v240
  v_mul_f32 v219, v219, v240
  v_cvt_pk_bf16_f32 v80, v216, v217
  v_cvt_pk_bf16_f32 v81, v218, v219
  ds_write_b64 v64, v[80:81] offset:4672
  v_mul_f32 v220, v220, v240
  v_mul_f32 v221, v221, v240
  v_mul_f32 v222, v222, v240
  v_mul_f32 v223, v223, v240
  v_cvt_pk_bf16_f32 v82, v220, v221
  v_cvt_pk_bf16_f32 v83, v222, v223
  ds_write_b64 v64, v[82:83] offset:4688
  v_mul_f32 v224, v224, v240
  v_mul_f32 v225, v225, v240
  v_mul_f32 v226, v226, v240
  v_mul_f32 v227, v227, v240
  v_cvt_pk_bf16_f32 v84, v224, v225
  v_cvt_pk_bf16_f32 v85, v226, v227
  ds_write_b64 v64, v[84:85] offset:4704
  v_mul_f32 v228, v228, v240
  v_mul_f32 v229, v229, v240
  v_mul_f32 v230, v230, v240
  v_mul_f32 v231, v231, v240
  v_cvt_pk_bf16_f32 v86, v228, v229
  v_cvt_pk_bf16_f32 v87, v230, v231
  s_waitcnt lgkmcnt(13)
  ds_write_b64 v64, v[86:87] offset:4720
  v_mul_f32 v36, v36, v241
  v_mul_f32 v37, v37, v241
  v_mul_f32 v38, v38, v241
  v_mul_f32 v39, v39, v241
  v_cvt_pk_bf16_f32 v36, v36, v37
  v_cvt_pk_bf16_f32 v37, v38, v39
  ds_write_b64 v65, v[36:37] offset:9216
  v_mul_f32 v40, v40, v241
  v_mul_f32 v41, v41, v241
  v_mul_f32 v42, v42, v241
  v_mul_f32 v43, v43, v241
  v_cvt_pk_bf16_f32 v40, v40, v41
  v_cvt_pk_bf16_f32 v41, v42, v43
  s_waitcnt lgkmcnt(13)
  ds_write_b64 v65, v[40:41] offset:9280
  s_waitcnt lgkmcnt(0)
  ds_read_b128 v[112:115], v66 offset:0
  ds_read_b128 v[116:119], v66 offset:1152
  ds_read_b128 v[120:123], v66 offset:2304
  ds_read_b128 v[124:127], v66 offset:3456
  ds_read_b128 v[128:131], v66 offset:4608
  ds_read_b128 v[132:135], v66 offset:5760
  ds_read_b128 v[136:139], v66 offset:6912
  ds_read_b128 v[140:143], v66 offset:8064
  ds_read_b128 v[144:147], v66 offset:9216
  s_waitcnt lgkmcnt(8)
  buffer_store_dwordx4 v[112:115], v67, s[24:27], s52 offen nt
  s_waitcnt lgkmcnt(7)
  buffer_store_dwordx4 v[116:119], v67, s[24:27], s53 offen nt
  s_waitcnt lgkmcnt(6)
  buffer_store_dwordx4 v[120:123], v67, s[24:27], s54 offen nt
  s_waitcnt lgkmcnt(5)
  buffer_store_dwordx4 v[124:127], v67, s[24:27], s55 offen nt
  s_waitcnt lgkmcnt(4)
  buffer_store_dwordx4 v[128:131], v67, s[24:27], s56 offen nt
  s_waitcnt lgkmcnt(3)
  buffer_store_dwordx4 v[132:135], v67, s[24:27], s57 offen nt
  s_waitcnt lgkmcnt(2)
  buffer_store_dwordx4 v[136:139], v67, s[24:27], s58 offen nt
  s_waitcnt lgkmcnt(1)
  buffer_store_dwordx4 v[140:143], v67, s[24:27], s59 offen nt
  s_waitcnt lgkmcnt(0)
  buffer_store_dwordx4 v[144:147], v67, s[24:27], s3 offen nt
  s_endpgm
L_fallback_v0:
  s_nop 15
  v_mov_b32 v242, 0xff800000
  v_mov_b32 v243, 0xff800000
  v_mov_b32 v244, 0xff800000
  s_mov_b32 s35, 0
L_fb_loop_v0:
  s_add_u32 m0, s30, 0
  s_nop 0
  buffer_load_dwordx4 v10, s[64:67], s35 offen offset:0 lds
  buffer_load_dwordx4 v11, s[64:67], s35 offen offset:1024 lds
  buffer_load_dwordx4 v12, s[64:67], s35 offen offset:2048 lds
  buffer_load_dwordx4 v13, s[64:67], s35 offen offset:3072 lds
  s_add_u32 m0, s30, 4096
  s_nop 0
  buffer_load_dwordx4 v10, s[68:71], s35 offen offset:0 lds
  buffer_load_dwordx4 v11, s[68:71], s35 offen offset:1024 lds
  buffer_load_dwordx4 v12, s[68:71], s35 offen offset:2048 lds
  buffer_load_dwordx4 v13, s[68:71], s35 offen offset:3072 lds
  s_add_u32 m0, s30, 8192
  s_nop 0
  buffer_load_dwordx4 v10, s[72:75], s35 offen offset:0 lds
  buffer_load_dwordx4 v11, s[72:75], s35 offen offset:1024 lds
  buffer_load_dwordx4 v12, s[72:75], s35 offen offset:2048 lds
  buffer_load_dwordx4 v13, s[72:75], s35 offen offset:3072 lds
  s_add_u32 m0, s30, 12288
  s_nop 0
  buffer_load_dwordx4 v10, s[76:79], s35 offen offset:0 lds
  buffer_load_dwordx4 v11, s[76:79], s35 offen offset:1024 lds
  buffer_load_dwordx4 v12, s[76:79], s35 offen offset:2048 lds
  buffer_load_dwordx4 v13, s[76:79], s35 offen offset:3072 lds
  s_waitcnt vmcnt(0)
  ds_read_b128 v[136:139], v18 offset:0
  s_waitcnt lgkmcnt(0)
  v_mfma_f32_32x32x16_bf16 v[64:79], v[136:139], a[0:3], 0
  v_mfma_f32_32x32x16_bf16 v[80:95], v[136:139], a[64:67], 0
  v_mfma_f32_16x16x32_bf16 v[96:99], v[136:139], a[128:131], 0
  ds_read_b128 v[140:143], v19 offset:0
  s_waitcnt lgkmcnt(0)
  v_mfma_f32_32x32x16_bf16 v[64:79], v[140:143], a[4:7], v[64:79]
  v_mfma_f32_32x32x16_bf16 v[80:95], v[140:143], a[68:71], v[80:95]
  v_mfma_f32_16x16x32_bf16 v[96:99], v[140:143], a[132:135], v[96:99]
  ds_read_b128 v[144:147], v20 offset:0
  s_waitcnt lgkmcnt(0)
  v_mfma_f32_32x32x16_bf16 v[64:79], v[144:147], a[8:11], v[64:79]
  v_mfma_f32_32x32x16_bf16 v[80:95], v[144:147], a[72:75], v[80:95]
  v_mfma_f32_16x16x32_bf16 v[96:99], v[144:147], a[136:139], v[96:99]
  ds_read_b128 v[148:151], v21 offset:0
  s_waitcnt lgkmcnt(0)
  v_mfma_f32_32x32x16_bf16 v[64:79], v[148:151], a[12:15], v[64:79]
  v_mfma_f32_32x32x16_bf16 v[80:95], v[148:151], a[76:79], v[80:95]
  v_mfma_f32_16x16x32_bf16 v[96:99], v[148:151], a[140:143], v[96:99]
  ds_read_b128 v[152:155], v18 offset:4096
  s_waitcnt lgkmcnt(0)
  v_mfma_f32_32x32x16_bf16 v[64:79], v[152:155], a[16:19], v[64:79]
  v_mfma_f32_32x32x16_bf16 v[80:95], v[152:155], a[80:83], v[80:95]
  v_mfma_f32_16x16x32_bf16 v[96:99], v[152:155], a[144:147], v[96:99]
  ds_read_b128 v[156:159], v19 offset:4096
  s_waitcnt lgkmcnt(0)
  v_mfma_f32_32x32x16_bf16 v[64:79], v[156:159], a[20:23], v[64:79]
  v_mfma_f32_32x32x16_bf16 v[80:95], v[156:159], a[84:87], v[80:95]
  v_mfma_f32_16x16x32_bf16 v[96:99], v[156:159], a[148:151], v[96:99]
  ds_read_b128 v[160:163], v20 offset:4096
  s_waitcnt lgkmcnt(0)
  v_mfma_f32_32x32x16_bf16 v[64:79], v[160:163], a[24:27], v[64:79]
  v_mfma_f32_32x32x16_bf16 v[80:95], v[160:163], a[88:91], v[80:95]
  v_mfma_f32_16x16x32_bf16 v[96:99], v[160:163], a[152:155], v[96:99]
  ds_read_b128 v[164:167], v21 offset:4096
  s_waitcnt lgkmcnt(0)
  v_mfma_f32_32x32x16_bf16 v[64:79], v[164:167], a[28:31], v[64:79]
  v_mfma_f32_32x32x16_bf16 v[80:95], v[164:167], a[92:95], v[80:95]
  v_mfma_f32_16x16x32_bf16 v[96:99], v[164:167], a[156:159], v[96:99]
  ds_read_b128 v[136:139], v18 offset:8192
  s_waitcnt lgkmcnt(0)
  v_mfma_f32_32x32x16_bf16 v[64:79], v[136:139], a[32:35], v[64:79]
  v_mfma_f32_32x32x16_bf16 v[80:95], v[136:139], a[96:99], v[80:95]
  v_mfma_f32_16x16x32_bf16 v[96:99], v[136:139], a[160:163], v[96:99]
  ds_read_b128 v[140:143], v19 offset:8192
  s_waitcnt lgkmcnt(0)
  v_mfma_f32_32x32x16_bf16 v[64:79], v[140:143], a[36:39], v[64:79]
  v_mfma_f32_32x32x16_bf16 v[80:95], v[140:143], a[100:103], v[80:95]
  v_mfma_f32_16x16x32_bf16 v[96:99], v[140:143], a[164:167], v[96:99]
  ds_read_b128 v[144:147], v20 offset:8192
  s_waitcnt lgkmcnt(0)
  v_mfma_f32_32x32x16_bf16 v[64:79], v[144:147], a[40:43], v[64:79]
  v_mfma_f32_32x32x16_bf16 v[80:95], v[144:147], a[104:107], v[80:95]
  v_mfma_f32_16x16x32_bf16 v[96:99], v[144:147], a[168:171], v[96:99]
  ds_read_b128 v[148:151], v21 offset:8192
  s_waitcnt lgkmcnt(0)
  v_mfma_f32_32x32x16_bf16 v[64:79], v[148:151], a[44:47], v[64:79]
  v_mfma_f32_32x32x16_bf16 v[80:95], v[148:151], a[108:111], v[80:95]
  v_mfma_f32_16x16x32_bf16 v[96:99], v[148:151], a[172:175], v[96:99]
  ds_read_b128 v[152:155], v18 offset:12288
  s_waitcnt lgkmcnt(0)
  v_mfma_f32_32x32x16_bf16 v[64:79], v[152:155], a[48:51], v[64:79]
  v_mfma_f32_32x32x16_bf16 v[80:95], v[152:155], a[112:115], v[80:95]
  v_mfma_f32_16x16x32_bf16 v[96:99], v[152:155], a[176:179], v[96:99]
  ds_read_b128 v[156:159], v19 offset:12288
  s_waitcnt lgkmcnt(0)
  v_mfma_f32_32x32x16_bf16 v[64:79], v[156:159], a[52:55], v[64:79]
  v_mfma_f32_32x32x16_bf16 v[80:95], v[156:159], a[116:119], v[80:95]
  v_mfma_f32_16x16x32_bf16 v[96:99], v[156:159], a[180:183], v[96:99]
  ds_read_b128 v[160:163], v20 offset:12288
  s_waitcnt lgkmcnt(0)
  v_mfma_f32_32x32x16_bf16 v[64:79], v[160:163], a[56:59], v[64:79]
  v_mfma_f32_32x32x16_bf16 v[80:95], v[160:163], a[120:123], v[80:95]
  v_mfma_f32_16x16x32_bf16 v[96:99], v[160:163], a[184:187], v[96:99]
  ds_read_b128 v[164:167], v21 offset:12288
  s_waitcnt lgkmcnt(0)
  v_mfma_f32_32x32x16_bf16 v[64:79], v[164:167], a[60:63], v[64:79]
  v_mfma_f32_32x32x16_bf16 v[80:95], v[164:167], a[124:127], v[80:95]
  v_mfma_f32_16x16x32_bf16 v[96:99], v[164:167], a[188:191], v[96:99]
  s_nop 9
  v_max3_f32 v242, v242, v64, v65
  v_max3_f32 v242, v242, v66, v67
  v_max3_f32 v242, v242, v68, v69
  v_max3_f32 v242, v242, v70, v71
  v_max3_f32 v242, v242, v72, v73
  v_max3_f32 v242, v242, v74, v75
  v_max3_f32 v242, v242, v76, v77
  v_max3_f32 v242, v242, v78, v79
  v_max3_f32 v243, v243, v80, v81
  v_max3_f32 v243, v243, v82, v83
  v_max3_f32 v243, v243, v84, v85
  v_max3_f32 v243, v243, v86, v87
  v_max3_f32 v243, v243, v88, v89
  v_max3_f32 v243, v243, v90, v91
  v_max3_f32 v243, v243, v92, v93
  v_max3_f32 v243, v243, v94, v95
  v_max3_f32 v244, v244, v96, v97
  v_max3_f32 v244, v244, v98, v99
  s_nop 7
  s_add_u32 s35, s35, 4096
  s_cmp_lt_u32 s35, 32768
  s_cbranch_scc1 L_fb_loop_v0
  v_max_f32_dpp v248, v244, v244 row_ror:8 row_mask:0xf bank_mask:0xf
  v_mov_b32 v246, v242
  v_mov_b32 v247, v243
  v_mov_b32 v244, v248
  v_permlane32_swap_b32 v242, v246
  v_permlane32_swap_b32 v243, v247
  v_permlane16_swap_b32 v244, v248
  v_max_f32 v242, v242, v246
  v_max_f32 v243, v243, v247
  v_max_f32 v244, v244, v248
  v_mov_b32 v248, v244
  s_nop 1
  v_permlane32_swap_b32 v244, v248
  v_max_f32 v244, v244, v248
  ds_write_b32 v56, v242
  ds_write_b32 v56, v243 offset:512
  ds_write_b32 v57, v244
  s_waitcnt lgkmcnt(0)
  s_barrier
  s_mov_b32 s33, 1
  s_branch L_main_v0
L_done:
  s_endpgm
.section .rodata,"a"
.p2align 6
.amdhsa_kernel standalone__gqa_softmax__near_ridge_kernel
  .amdhsa_next_free_vgpr 512
  .amdhsa_next_free_sgpr 102
  .amdhsa_accum_offset 256
  .amdhsa_group_segment_fixed_size 0
  .amdhsa_kernarg_size 48
  .amdhsa_user_sgpr_count 2
  .amdhsa_user_sgpr_kernarg_segment_ptr 1
  .amdhsa_system_sgpr_workgroup_id_x 1
.end_amdhsa_kernel
```
